```python
import torch

def _softmax(x, axis=-1):
    return torch.softmax(x, dim=axis)
def _gelu(x):
    return torch.nn.functional.gelu(x, approximate="tanh")
def _silu(x):
    return torch.nn.functional.silu(x)
def _sigmoid(x):
    return torch.sigmoid(x)
def _layernorm(x, axis=-1, eps=1e-5):
    m = x.mean(dim=axis, keepdim=True)
    v = x.var(dim=axis, keepdim=True, unbiased=False)
    return (x - m) / torch.sqrt(v + eps)
def _scatter_add(tgt, idx, src, axis=0):
    return tgt.clone().index_add_(axis, idx, src)
def _segment_sum(src, seg, n):
    out = torch.zeros((n,) + src.shape[1:], dtype=src.dtype)
    return out.index_add_(0, seg, src)
def _pad(x, pw):
    flat = tuple(v for pair in reversed(pw) for v in pair)
    return torch.nn.functional.pad(x, flat)

kernel_name = 'gather_scatter__isomorphism_gin_2__graph'

def setup_inputs():

    _w = (lambda a: (lambda t: t.to(torch.bfloat16) if t.is_floating_point() else t)(torch.as_tensor(a)))
    N, deg, D = 10000, 16, 256
    E = N * deg
    H = 2 * D
    src = (lambda lo, hi, *s: torch.randint(lo, hi, s))(0, N, E).to(torch.int64)
    dst = (lambda lo, hi, *s: torch.randint(lo, hi, s))(0, N, E).to(torch.int64)
    return {
        "x": _w((lambda *s: torch.randn(*s, dtype=torch.bfloat16) * 0.05)(N, D)),
        "src": _w(src),
        "dst": _w(dst),
        "eps": _w((lambda *s: torch.randn(*s, dtype=torch.bfloat16) * 0.05)(1) * 0.1),
        "w1": _w((lambda *s: torch.randn(*s, dtype=torch.bfloat16) * 0.05)(D, H) * D ** -0.5),
        "b1": _w((lambda *s: torch.randn(*s, dtype=torch.bfloat16) * 0.4)(H) * 0.01),
        "w2": _w((lambda *s: torch.randn(*s, dtype=torch.bfloat16) * 0.05)(H, D) * H ** -0.5),
        "b2": _w((lambda *s: torch.randn(*s, dtype=torch.bfloat16) * 0.05)(D) * 0.01),
    }

def reference(x, src, dst, eps, w1, b1, w2, b2):
    N = x.shape[0]
    agg = _segment_sum(x[src], dst, N)
    h = (1.0 + eps) * x + agg
    h = torch.einsum('nd,dh->nh', h, w1) + b1
    h = torch.where(h > 0, h, 0.0 * h)
    h = torch.einsum('nh,hd->nd', h, w2) + b2
    return h
```

```asm
; @launch grid=(256,1,1) block=(512,1,1) lds=142336
.amdgcn_target "amdgcn-amd-amdhsa--gfx950"
.text
.globl gather_scatter__isomorphism_gin_2__graph_kernel
.p2align 8
.type gather_scatter__isomorphism_gin_2__graph_kernel,@function
gather_scatter__isomorphism_gin_2__graph_kernel:
    s_cmp_ge_u32 s2, 256
    s_cbranch_scc1 M_END
    s_load_dwordx16 s[76:91], s[0:1], 0
    s_load_dwordx4 s[4:7], s[0:1], 64
    s_load_dwordx2 s[100:101], s[0:1], 80
    v_and_b32 v1, 63, v0
    v_lshrrev_b32 v5, 6, v0
    v_lshlrev_b32 v57, 4, v0
    v_readfirstlane_b32 s36, v5
    s_cmp_lt_u32 s2, 32
    s_cbranch_scc0 NOTP
    s_mul_i32 s38, s2, 20000
    s_add_u32 s40, s38, 8192
    s_add_u32 s41, s38, 16384
    s_mov_b32 s26, 640000
    s_mov_b32 s27, 0x00020000
    s_mov_b32 s22, 640000
    s_mov_b32 s23, 0x00020000
    s_waitcnt lgkmcnt(0)
    s_mov_b32 s24, s80
    s_and_b32 s25, s81, 0xffff
    buffer_load_dwordx4 v[16:19], v57, s[24:27], s38 offen
    buffer_load_dwordx4 v[24:27], v57, s[24:27], s40 offen
    s_mov_b32 s20, s78
    s_and_b32 s21, s79, 0xffff
    s_cmp_lt_u32 s36, 4
    s_cbranch_scc0 P_E2
    buffer_load_dwordx4 v[32:35], v57, s[24:27], s41 offen
    buffer_load_dwordx4 v[36:39], v57, s[20:23], s41 offen
P_E2:
    buffer_load_dwordx4 v[20:23], v57, s[20:23], s38 offen
    buffer_load_dwordx4 v[28:31], v57, s[20:23], s40 offen
    s_branch AUX
NOTP:
    s_cmp_lt_u32 s2, 47
    s_cbranch_scc1 AUX
    s_sub_u32 s3, s2, 47
    s_lshl_b32 s46, s3, 13
    s_mul_i32 s3, s3, 48
    v_mov_b32 v58, 65536
    v_cmp_gt_u32 vcc, 384, v0
    v_add_u32 v7, v58, v57
    s_nop 0
    v_cndmask_b32 v36, 0, -1, vcc
    v_mov_b32 v37, v36
    v_mov_b32 v38, v36
    v_mov_b32 v39, v36
    ds_write_b128 v7, v[36:39]
    s_lshr_b32 s47, s2, 3
    s_and_b32 s47, s47, 7
    s_lshr_b32 s49, s2, 4
    s_and_b32 s49, s49, 4
    s_and_b32 s38, s47, 3
    s_or_b32 s49, s49, s38
    s_xor_b32 s49, s36, s49
    v_bfe_u32 v5, v1, 1, 2
    v_bfe_u32 v6, v1, 4, 1
    v_xor_b32 v5, v5, v6
    v_lshrrev_b32 v6, 3, v1
    v_lshlrev_b32 v6, 10, v6
    v_and_b32 v7, 1, v1
    v_lshl_or_b32 v6, v7, 4, v6
    s_lshl_b32 s38, s49, 7
    v_or_b32 v6, s38, v6
    v_lshl_or_b32 v16, v5, 5, v6
    v_xor_b32 v17, 64, v16
    s_lshl_b32 s48, s36, 13
    s_add_u32 s37, s48, 73728
    s_lshl_b32 s39, s47, 15
    s_waitcnt lgkmcnt(0)
    s_mov_b32 s64, s84
    s_and_b32 s65, s85, 0xffff
    s_mov_b32 s66, 262144
    s_mov_b32 s67, 0x00020000
    s_barrier
    s_setprio 3
    s_add_u32 m0, s37, 0
    s_xor_b32 s38, s39, 0
    buffer_load_dwordx4 v16, s[64:67], s38 offen lds
    s_add_u32 m0, s37, 1024
    s_xor_b32 s38, s39, 8192
    buffer_load_dwordx4 v17, s[64:67], s38 offen lds
    s_add_u32 m0, s37, 2048
    s_xor_b32 s38, s39, 16384
    buffer_load_dwordx4 v16, s[64:67], s38 offen lds
    s_add_u32 m0, s37, 3072
    s_xor_b32 s38, s39, 24576
    buffer_load_dwordx4 v17, s[64:67], s38 offen lds
    s_setprio 2
    s_load_dword s45, s[82:83], 0
    s_add_u32 m0, s37, 4096
    s_xor_b32 s38, s39, 32768
    buffer_load_dwordx4 v16, s[64:67], s38 offen lds
    s_add_u32 m0, s37, 5120
    s_xor_b32 s38, s39, 40960
    buffer_load_dwordx4 v17, s[64:67], s38 offen lds
    s_add_u32 m0, s37, 6144
    s_xor_b32 s38, s39, 49152
    buffer_load_dwordx4 v16, s[64:67], s38 offen lds
    s_add_u32 m0, s37, 7168
    s_xor_b32 s38, s39, 57344
    buffer_load_dwordx4 v17, s[64:67], s38 offen lds
    s_add_u32 m0, s48, 0
    s_xor_b32 s38, s39, 65536
    buffer_load_dwordx4 v16, s[64:67], s38 offen lds
    s_add_u32 m0, s48, 1024
    s_xor_b32 s38, s39, 73728
    buffer_load_dwordx4 v17, s[64:67], s38 offen lds
    s_add_u32 m0, s48, 2048
    s_xor_b32 s38, s39, 81920
    buffer_load_dwordx4 v16, s[64:67], s38 offen lds
    s_add_u32 m0, s48, 3072
    s_xor_b32 s38, s39, 90112
    buffer_load_dwordx4 v17, s[64:67], s38 offen lds
    s_add_u32 m0, s48, 4096
    s_xor_b32 s38, s39, 98304
    buffer_load_dwordx4 v16, s[64:67], s38 offen lds
    s_add_u32 m0, s48, 5120
    s_xor_b32 s38, s39, 106496
    buffer_load_dwordx4 v17, s[64:67], s38 offen lds
    s_add_u32 m0, s48, 6144
    s_xor_b32 s38, s39, 114688
    buffer_load_dwordx4 v16, s[64:67], s38 offen lds
    s_add_u32 m0, s48, 7168
    s_xor_b32 s38, s39, 122880
    buffer_load_dwordx4 v17, s[64:67], s38 offen lds
    s_mov_b32 s28, s86
    s_and_b32 s29, s87, 0xffff
    s_mov_b32 s30, 1024
    s_mov_b32 s31, 0x00020000
    s_mov_b32 s32, s90
    s_and_b32 s33, s91, 0xffff
    s_mov_b32 s34, 512
    s_mov_b32 s35, 0x00020000
    v_lshlrev_b32 v2, 4, v1
    s_cmp_eq_u32 s36, 2
    s_cbranch_scc0 C_SL2
    buffer_load_dwordx4 v[44:47], v2, s[28:31], 0 offen
C_SL2:
    s_cmp_eq_u32 s36, 3
    s_cbranch_scc0 C_SL3
    buffer_load_dwordx4 v[44:47], v2, s[32:35], 0 offen
C_SL3:
    v_lshrrev_b32 v5, 4, v1
    v_lshlrev_b32 v5, 10, v5
    v_bfe_u32 v6, v1, 2, 2
    v_lshl_or_b32 v5, v6, 7, v5
    v_and_b32 v6, 3, v1
    v_lshl_or_b32 v5, v6, 3, v5
    v_bfe_u32 v6, v1, 3, 2
    v_xor_b32 v7, 0, v6
    v_lshl_add_u32 v7, v7, 5, v5
    v_add_u32 v20, s37, v7
    v_add_u32 v24, s48, v7
    v_xor_b32 v7, 1, v6
    v_lshl_add_u32 v7, v7, 5, v5
    v_add_u32 v21, s37, v7
    v_add_u32 v25, s48, v7
    v_xor_b32 v7, 2, v6
    v_lshl_add_u32 v7, v7, 5, v5
    v_add_u32 v22, s37, v7
    v_add_u32 v26, s48, v7
    v_xor_b32 v7, 3, v6
    v_lshl_add_u32 v7, v7, 5, v5
    v_add_u32 v23, s37, v7
    v_add_u32 v27, s48, v7
    s_waitcnt lgkmcnt(0)
    s_waitcnt vmcnt(12)
    ds_read_b64_tr_b16 v[128:129], v20 offset:0
    ds_read_b64_tr_b16 v[130:131], v20 offset:512
    ds_read_b64_tr_b16 v[132:133], v21 offset:0
    ds_read_b64_tr_b16 v[134:135], v21 offset:512
    ds_read_b64_tr_b16 v[136:137], v22 offset:0
    ds_read_b64_tr_b16 v[138:139], v22 offset:512
    ds_read_b64_tr_b16 v[140:141], v23 offset:0
    ds_read_b64_tr_b16 v[142:143], v23 offset:512
    s_waitcnt lgkmcnt(0)
    s_add_u32 m0, s37, 0
    s_xor_b32 s38, s39, 131072
    buffer_load_dwordx4 v16, s[64:67], s38 offen lds
    s_add_u32 m0, s37, 1024
    s_xor_b32 s38, s39, 139264
    buffer_load_dwordx4 v17, s[64:67], s38 offen lds
    s_add_u32 m0, s37, 2048
    s_xor_b32 s38, s39, 147456
    buffer_load_dwordx4 v16, s[64:67], s38 offen lds
    s_add_u32 m0, s37, 3072
    s_xor_b32 s38, s39, 155648
    buffer_load_dwordx4 v17, s[64:67], s38 offen lds
    s_lshl_b32 s38, s49, 15
    s_add_u32 s38, s38, 2097152
    v_lshl_add_u32 v56, v1, 4, s38
    s_waitcnt vmcnt(12)
    ds_read_b64_tr_b16 v[144:145], v20 offset:4096
    ds_read_b64_tr_b16 v[146:147], v20 offset:4608
    ds_read_b64_tr_b16 v[148:149], v21 offset:4096
    ds_read_b64_tr_b16 v[150:151], v21 offset:4608
    ds_read_b64_tr_b16 v[152:153], v22 offset:4096
    ds_read_b64_tr_b16 v[154:155], v22 offset:4608
    ds_read_b64_tr_b16 v[156:157], v23 offset:4096
    ds_read_b64_tr_b16 v[158:159], v23 offset:4608
    s_waitcnt lgkmcnt(0)
    s_add_u32 m0, s37, 4096
    s_xor_b32 s38, s39, 163840
    buffer_load_dwordx4 v16, s[64:67], s38 offen lds
    s_add_u32 m0, s37, 5120
    s_xor_b32 s38, s39, 172032
    buffer_load_dwordx4 v17, s[64:67], s38 offen lds
    s_add_u32 m0, s37, 6144
    s_xor_b32 s38, s39, 180224
    buffer_load_dwordx4 v16, s[64:67], s38 offen lds
    s_add_u32 m0, s37, 7168
    s_xor_b32 s38, s39, 188416
    buffer_load_dwordx4 v17, s[64:67], s38 offen lds
    s_mov_b32 s8, s76
    s_and_b32 s9, s77, 0xffff
    s_mov_b32 s10, 5120000
    s_mov_b32 s11, 0x00020000
    s_mov_b32 s72, s6
    s_and_b32 s73, s7, 0xffff
    s_mov_b32 s74, 256
    s_mov_b32 s75, 0x00020000
    s_mov_b32 s12, s100
    s_and_b32 s13, s101, 0xffff
    s_mov_b32 s14, 2359296
    s_mov_b32 s15, 0x00020000
    s_mov_b32 s16, s4
    s_and_b32 s17, s5, 0xffff
    s_mov_b32 s18, 5120000
    s_mov_b32 s19, 0x00020000
    s_mov_b32 s24, s80
    s_and_b32 s25, s81, 0xffff
    s_mov_b32 s26, 640000
    s_mov_b32 s27, 0x00020000
    s_mov_b32 s20, s78
    s_and_b32 s21, s79, 0xffff
    s_mov_b32 s22, 640000
    s_mov_b32 s23, 0x00020000
    s_setprio 1
    s_waitcnt vmcnt(12)
    ds_read_b64_tr_b16 v[160:161], v24 offset:0
    ds_read_b64_tr_b16 v[162:163], v24 offset:512
    ds_read_b64_tr_b16 v[164:165], v25 offset:0
    ds_read_b64_tr_b16 v[166:167], v25 offset:512
    ds_read_b64_tr_b16 v[168:169], v26 offset:0
    ds_read_b64_tr_b16 v[170:171], v26 offset:512
    ds_read_b64_tr_b16 v[172:173], v27 offset:0
    ds_read_b64_tr_b16 v[174:175], v27 offset:512
    s_waitcnt lgkmcnt(0)
    s_add_u32 m0, s48, 0
    s_xor_b32 s38, s39, 196608
    buffer_load_dwordx4 v16, s[64:67], s38 offen lds
    s_add_u32 m0, s48, 1024
    s_xor_b32 s38, s39, 204800
    buffer_load_dwordx4 v17, s[64:67], s38 offen lds
    s_add_u32 m0, s48, 2048
    s_xor_b32 s38, s39, 212992
    buffer_load_dwordx4 v16, s[64:67], s38 offen lds
    s_add_u32 m0, s48, 3072
    s_xor_b32 s38, s39, 221184
    buffer_load_dwordx4 v17, s[64:67], s38 offen lds
    v_lshrrev_b32 v5, 4, v1
    v_lshrrev_b32 v6, 3, v1
    v_xor_b32 v5, v5, v6
    v_and_b32 v5, 1, v5
    v_bfe_u32 v6, v1, 1, 2
    v_lshl_or_b32 v5, v5, 2, v6
    v_and_b32 v6, 1, v1
    v_lshlrev_b32 v6, 4, v6
    s_lshl_b32 s45, s45, 16
    v_mov_b32 v40, s45
    v_add_f32 v40, 1.0, v40
    v_cvt_pk_bf16_f32 v40, v40, v40
    v_and_b32 v40, 0xffff, v40
    v_mov_b32 v41, 0x3f80
    v_lshlrev_b32 v40, v6, v40
    v_lshlrev_b32 v41, v6, v41
    v_cmp_gt_u32 vcc, 32, v1
    s_nop 1
    v_cndmask_b32 v42, v40, 0, vcc
    v_cndmask_b32 v40, 0, v40, vcc
    v_cmp_eq_u32 vcc, 0, v5
    s_nop 1
    v_cndmask_b32 v48, 0, v41, vcc
    v_cndmask_b32 v52, 0, v40, vcc
    v_cndmask_b32 v124, 0, v42, vcc
    v_cmp_eq_u32 vcc, 1, v5
    s_nop 1
    v_cndmask_b32 v49, 0, v41, vcc
    v_cndmask_b32 v53, 0, v40, vcc
    v_cndmask_b32 v125, 0, v42, vcc
    v_cmp_eq_u32 vcc, 2, v5
    s_nop 1
    v_cndmask_b32 v50, 0, v41, vcc
    v_cndmask_b32 v54, 0, v40, vcc
    v_cndmask_b32 v126, 0, v42, vcc
    v_cmp_eq_u32 vcc, 3, v5
    s_nop 1
    v_cndmask_b32 v51, 0, v41, vcc
    v_cndmask_b32 v55, 0, v40, vcc
    v_cndmask_b32 v127, 0, v42, vcc
    s_waitcnt vmcnt(12)
    ds_read_b64_tr_b16 v[176:177], v24 offset:4096
    ds_read_b64_tr_b16 v[178:179], v24 offset:4608
    ds_read_b64_tr_b16 v[180:181], v25 offset:4096
    ds_read_b64_tr_b16 v[182:183], v25 offset:4608
    ds_read_b64_tr_b16 v[184:185], v26 offset:4096
    ds_read_b64_tr_b16 v[186:187], v26 offset:4608
    ds_read_b64_tr_b16 v[188:189], v27 offset:4096
    ds_read_b64_tr_b16 v[190:191], v27 offset:4608
    s_waitcnt lgkmcnt(0)
    s_add_u32 m0, s48, 4096
    s_xor_b32 s38, s39, 229376
    buffer_load_dwordx4 v16, s[64:67], s38 offen lds
    s_add_u32 m0, s48, 5120
    s_xor_b32 s38, s39, 237568
    buffer_load_dwordx4 v17, s[64:67], s38 offen lds
    s_add_u32 m0, s48, 6144
    s_xor_b32 s38, s39, 245760
    buffer_load_dwordx4 v16, s[64:67], s38 offen lds
    s_add_u32 m0, s48, 7168
    s_xor_b32 s38, s39, 253952
    buffer_load_dwordx4 v17, s[64:67], s38 offen lds
    s_waitcnt vmcnt(12)
    ds_read_b64_tr_b16 v[192:193], v20 offset:0
    ds_read_b64_tr_b16 v[194:195], v20 offset:512
    ds_read_b64_tr_b16 v[196:197], v21 offset:0
    ds_read_b64_tr_b16 v[198:199], v21 offset:512
    ds_read_b64_tr_b16 v[200:201], v22 offset:0
    ds_read_b64_tr_b16 v[202:203], v22 offset:512
    ds_read_b64_tr_b16 v[204:205], v23 offset:0
    ds_read_b64_tr_b16 v[206:207], v23 offset:512
    s_sub_u32 s38, s36, 2
    s_cmp_lt_u32 s38, 2
    s_cbranch_scc0 C_NB
    v_lshlrev_b32 v32, 16, v44
    v_and_b32 v33, 0xffff0000, v44
    v_lshlrev_b32 v34, 16, v45
    v_and_b32 v35, 0xffff0000, v45
    v_lshlrev_b32 v36, 16, v46
    v_and_b32 v37, 0xffff0000, v46
    v_lshlrev_b32 v38, 16, v47
    v_and_b32 v39, 0xffff0000, v47
    s_lshl_b32 s38, s38, 11
    s_add_u32 s38, s38, 139264
    v_lshl_add_u32 v7, v1, 5, s38
    s_cmp_eq_u32 s36, 3
    s_cbranch_scc0 C_NB2
    s_mov_b64 exec, 0xffffffff
C_NB2:
    ds_write_b128 v7, v[32:35]
    ds_write_b128 v7, v[36:39] offset:16
    s_mov_b64 exec, -1
    s_waitcnt lgkmcnt(0)
C_NB:
    s_setprio 0
    s_waitcnt vmcnt(8)
    ds_read_b64_tr_b16 v[208:209], v20 offset:4096
    ds_read_b64_tr_b16 v[210:211], v20 offset:4608
    ds_read_b64_tr_b16 v[212:213], v21 offset:4096
    ds_read_b64_tr_b16 v[214:215], v21 offset:4608
    ds_read_b64_tr_b16 v[216:217], v22 offset:4096
    ds_read_b64_tr_b16 v[218:219], v22 offset:4608
    ds_read_b64_tr_b16 v[220:221], v23 offset:4096
    ds_read_b64_tr_b16 v[222:223], v23 offset:4608
    v_lshrrev_b32 v3, 5, v1
    v_lshlrev_b32 v3, 4, v3
    v_and_b32 v5, 15, v1
    v_lshlrev_b32 v8, 4, v5
    v_lshl_or_b32 v8, v3, 4, v8
    v_bfe_u32 v5, v1, 4, 1
    v_lshl_or_b32 v8, v5, 3, v8
    v_and_b32 v2, 31, v1
    v_lshlrev_b32 v2, 4, v2
    v_bfe_u32 v42, v1, 3, 2
    s_lshl_b32 s38, s36, 4
    v_lshl_add_u32 v42, v42, 2, s38
    v_and_b32 v43, 7, v1
    v_lshlrev_b32 v43, 2, v43
    s_lshl_b32 s38, s36, 9
    v_lshl_add_u32 v41, v3, 8, v2
    v_add_u32 v41, s38, v41
    s_mov_b32 s50, 0
    s_mov_b32 s52, 1032192
    v_lshrrev_b32 v5, 1, v1
    v_lshlrev_b32 v5, 4, v5
    v_and_b32 v6, 1, v1
    v_or_b32 v5, v5, v6
    s_lshl_b32 s54, s36, 1
    v_add_u32 v5, s54, v5
    v_cmp_gt_u32 vcc, 6, v1
    v_mov_b32 v6, 56
    v_mov_b32 v62, 64
    v_cndmask_b32 v5, v6, v5, vcc
    v_lshl_add_u32 v61, v5, 2, v58
    s_lshl_b32 s38, s36, 8
    v_lshl_add_u32 v6, v1, 2, v58
    v_add_u32 v60, s38, v6
    v_cndmask_b32 v62, 0, v62, vcc
    s_lshl_b32 s53, s54, 9
    s_and_b32 s44, s54, 15
    s_lshl_b32 s44, s44, 4
    s_or_b32 s53, s53, s44
    s_waitcnt vmcnt(4)
    ds_read_b64_tr_b16 v[224:225], v24 offset:0
    ds_read_b64_tr_b16 v[226:227], v24 offset:512
    ds_read_b64_tr_b16 v[228:229], v25 offset:0
    ds_read_b64_tr_b16 v[230:231], v25 offset:512
    ds_read_b64_tr_b16 v[232:233], v26 offset:0
    ds_read_b64_tr_b16 v[234:235], v26 offset:512
    ds_read_b64_tr_b16 v[236:237], v27 offset:0
    ds_read_b64_tr_b16 v[238:239], v27 offset:512
    s_cmp_lt_u32 s36, 4
    s_cbranch_scc1 C_OLD
    buffer_load_dword v40, v42, s[72:75], 0 offen sc1
    v_mov_b32 v39, 1
    buffer_load_dwordx4 v[32:35], v41, s[12:15], s46 offen sc1
    s_waitcnt vmcnt(2)
    ds_read_b64_tr_b16 v[240:241], v24 offset:4096
    ds_read_b64_tr_b16 v[242:243], v24 offset:4608
    ds_read_b64_tr_b16 v[244:245], v25 offset:4096
    ds_read_b64_tr_b16 v[246:247], v25 offset:4608
    ds_read_b64_tr_b16 v[248:249], v26 offset:4096
    ds_read_b64_tr_b16 v[250:251], v26 offset:4608
    ds_read_b64_tr_b16 v[252:253], v27 offset:4096
    ds_read_b64_tr_b16 v[254:255], v27 offset:4608
    s_waitcnt vmcnt(0)
    s_branch C_JOIN
C_OLD:
    s_waitcnt vmcnt(0)
    ds_read_b64_tr_b16 v[240:241], v24 offset:4096
    ds_read_b64_tr_b16 v[242:243], v24 offset:4608
    ds_read_b64_tr_b16 v[244:245], v25 offset:4096
    ds_read_b64_tr_b16 v[246:247], v25 offset:4608
    ds_read_b64_tr_b16 v[248:249], v26 offset:4096
    ds_read_b64_tr_b16 v[250:251], v26 offset:4608
    ds_read_b64_tr_b16 v[252:253], v27 offset:4096
    ds_read_b64_tr_b16 v[254:255], v27 offset:4608
    buffer_load_dword v40, v42, s[72:75], 0 offen sc1
    v_mov_b32 v39, 1
    buffer_load_dwordx4 v[32:35], v41, s[12:15], s46 offen sc1
    s_waitcnt vmcnt(0)
C_JOIN:
POLL_CHK:
    v_lshrrev_b32 v16, 8, v33
    v_lshrrev_b32 v17, 8, v35
    v_xor_b32 v16, v16, v40
    v_xor_b32 v17, v17, v40
    v_or_b32 v16, v16, v17
    v_alignbit_b32 v26, v35, v34, 20
    v_cmp_ne_u32 s[76:77], 0, v16
    v_and_b32 v26, 0xfffff, v26
    v_min_u32 v17, v40, v39
    v_cmp_eq_u32 s[78:79], 0, v17
    v_cmp_ne_u32 vcc, s52, v26
    s_and_b32 s5, vcc_lo, 0x80808080
    s_lshr_b32 s5, s5, 7
    s_mul_i32 s5, s5, 255
    s_mov_b32 s4, -1
    s_and_b64 s[76:77], s[76:77], s[4:5]
    s_or_b64 s[76:77], s[76:77], s[78:79]
    s_cbranch_scc1 POLL_RETRY
    v_and_b32 v20, 0xfffff, v32
    v_alignbit_b32 v22, v33, v32, 20
    v_and_b32 v22, 0xfffff, v22
    v_and_b32 v24, 0xfffff, v34
POLL_OK:
    s_add_u32 s6, s3, s54
    s_lshl_b32 s6, s6, 9
    v_lshl_add_u32 v28, v1, 4, s6
    buffer_load_dwordx4 v[112:115], v28, s[8:11], 0 offen
    v_add_u32 v29, 8192, v28
    buffer_load_dwordx4 v[116:119], v29, s[8:11], 0 offen
    v_add_u32 v30, 16384, v28
    buffer_load_dwordx4 v[120:123], v30, s[8:11], 0 offen
    v_mov_b32 v16, s52
    v_cndmask_b32 v20, v16, v20, s[4:5]
    s_mov_b32 s4, 1015808
    v_mov_b32 v41, 1
    v_bfe_u32 v21, v20, 14, 6
    v_lshl_add_u32 v16, v21, 2, v58
    v_bfe_u32 v23, v22, 14, 6
    v_lshl_add_u32 v17, v23, 2, v58
    v_bfe_u32 v25, v24, 14, 6
    v_lshl_add_u32 v18, v25, 2, v58
    v_bfe_u32 v27, v26, 14, 6
    v_lshl_add_u32 v19, v27, 2, v58
    v_cmpx_gt_u32 vcc, s4, v20
    ds_add_rtn_u32 v16, v16, v41 offset:6144
    s_mov_b64 s[76:77], exec
    v_cmpx_gt_u32 vcc, s4, v22
    ds_add_rtn_u32 v17, v17, v41 offset:6144
    s_mov_b64 s[78:79], exec
    v_cmpx_gt_u32 vcc, s4, v24
    ds_add_rtn_u32 v18, v18, v41 offset:6144
    s_mov_b64 s[80:81], exec
    v_cmpx_gt_u32 vcc, s4, v26
    ds_add_rtn_u32 v19, v19, v41 offset:6144
    s_mov_b64 s[82:83], exec
    s_mov_b64 exec, -1
    v_cmp_eq_u32 vcc, s4, v20
    s_and_saveexec_b64 s[6:7], vcc
    ds_write_b32 v58, v41 offset:6368
    s_mov_b64 exec, -1
    v_and_b32 v20, 0x3fff, v20
    v_lshl_add_u32 v21, v21, 7, v58
    v_and_b32 v22, 0x3fff, v22
    v_lshl_add_u32 v23, v23, 7, v58
    v_and_b32 v24, 0x3fff, v24
    v_lshl_add_u32 v25, v25, 7, v58
    v_and_b32 v26, 0x3fff, v26
    v_lshl_add_u32 v27, v27, 7, v58
    s_waitcnt lgkmcnt(0)
    v_min_u32 v16, 63, v16
    v_lshl_add_u32 v21, v16, 1, v21
    v_min_u32 v17, 63, v17
    v_lshl_add_u32 v23, v17, 1, v23
    v_min_u32 v18, 63, v18
    v_lshl_add_u32 v25, v18, 1, v25
    v_min_u32 v19, 63, v19
    v_lshl_add_u32 v27, v19, 1, v27
    s_mov_b64 exec, s[76:77]
    ds_write_b16 v21, v20
    s_mov_b64 exec, s[78:79]
    ds_write_b16 v23, v22
    s_mov_b64 exec, s[80:81]
    ds_write_b16 v25, v24
    s_mov_b64 exec, s[82:83]
    ds_write_b16 v27, v26
    s_mov_b64 exec, -1
    s_mov_b32 s56, 0
    s_mov_b32 s57, 0
    s_mov_b32 s51, 0
    s_mov_b32 s50, 6
    v_mov_b32 v64, v43
    buffer_load_dword v63, v43, s[72:75], 0 offen offset:128 sc1
    s_waitcnt lgkmcnt(0)
    s_barrier
    ds_read_b32 v61, v61 offset:6144
    ds_read_b32 v4, v60 offset:0
    ds_read_b32 v59, v60 offset:2048
    ds_read_b32 v60, v60 offset:4096
    s_setprio 3
    s_waitcnt lgkmcnt(2)
    v_cmp_gt_u32 vcc, v61, v62
    v_add_u32 v61, 1, v61
    v_lshrrev_b32 v61, 1, v61
    v_max_u32 v61, 1, v61
    s_cmp_lg_u64 vcc, 0
    s_cbranch_scc1 M_SLOW
    v_readlane_b32 s52, v61, 0
    s_waitcnt lgkmcnt(0)
F_0:
    v_readlane_b32 s55, v4, s51
    s_add_u32 s51, s51, 1
    s_cmp_eq_u32 s51, s52
    v_bfe_u32 v7, s55, v3, 16
    v_lshl_add_u32 v7, v7, 9, v2
    buffer_load_dwordx4 v[16:19], v7, s[8:11], 0 offen
    s_cbranch_scc1 F_SW0
F_1:
    v_readlane_b32 s55, v4, s51
    s_add_u32 s51, s51, 1
    s_cmp_eq_u32 s51, s52
    v_bfe_u32 v7, s55, v3, 16
    v_lshl_add_u32 v7, v7, 9, v2
    buffer_load_dwordx4 v[20:23], v7, s[8:11], 0 offen
    s_cbranch_scc1 F_SW1
F_2:
    v_readlane_b32 s55, v4, s51
    s_add_u32 s51, s51, 1
    s_cmp_eq_u32 s51, s52
    v_bfe_u32 v7, s55, v3, 16
    v_lshl_add_u32 v7, v7, 9, v2
    buffer_load_dwordx4 v[24:27], v7, s[8:11], 0 offen
    s_cbranch_scc1 F_SW2
F_3:
    v_readlane_b32 s55, v4, s51
    s_add_u32 s51, s51, 1
    s_cmp_eq_u32 s51, s52
    v_bfe_u32 v7, s55, v3, 16
    v_lshl_add_u32 v7, v7, 9, v2
    buffer_load_dwordx4 v[28:31], v7, s[8:11], 0 offen
    s_cbranch_scc1 F_SW3
F_4:
    v_readlane_b32 s55, v4, s51
    s_add_u32 s51, s51, 1
    s_cmp_eq_u32 s51, s52
    v_bfe_u32 v7, s55, v3, 16
    v_lshl_add_u32 v7, v7, 9, v2
    buffer_load_dwordx4 v[32:35], v7, s[8:11], 0 offen
    s_cbranch_scc1 F_SW4
F_5:
    v_readlane_b32 s55, v4, s51
    s_add_u32 s51, s51, 1
    s_cmp_eq_u32 s51, s52
    v_bfe_u32 v7, s55, v3, 16
    v_lshl_add_u32 v7, v7, 9, v2
    buffer_load_dwordx4 v[36:39], v7, s[8:11], 0 offen
    s_cbranch_scc1 F_SW5
F_6:
    v_readlane_b32 s55, v4, s51
    s_add_u32 s51, s51, 1
    s_cmp_eq_u32 s51, s52
    v_bfe_u32 v7, s55, v3, 16
    v_lshl_add_u32 v7, v7, 9, v2
    buffer_load_dwordx4 v[40:43], v7, s[8:11], 0 offen
    s_cbranch_scc1 F_SW6
F_7:
    v_readlane_b32 s55, v4, s51
    s_add_u32 s51, s51, 1
    s_cmp_eq_u32 s51, s52
    v_bfe_u32 v7, s55, v3, 16
    v_lshl_add_u32 v7, v7, 9, v2
    buffer_load_dwordx4 v[44:47], v7, s[8:11], 0 offen
    s_cbranch_scc1 F_SW7
    s_branch G_F0
F_SW0:
    s_bitset1_b32 s56, 0
    s_add_u32 s57, s57, 1
    s_cmp_eq_u32 s57, 6
    s_cbranch_scc1 X_F0
    v_readlane_b32 s52, v61, s57
    s_and_b32 s51, s57, 1
    s_cselect_b32 s4, 0, -1
    s_mov_b32 s5, s4
    s_lshl_b32 s51, s51, 5
    v_cndmask_b32 v4, v4, v59, s[4:5]
    v_cndmask_b32 v59, v59, v60, s[4:5]
    s_add_u32 s52, s52, s51
    s_cmp_lt_u32 s57, 3
    s_cbranch_scc1 SWP0
    s_setprio 2
    s_cmp_lt_u32 s57, 4
    s_cbranch_scc1 SWP0
    s_setprio 1
    s_cmp_lt_u32 s57, 5
    s_cbranch_scc1 SWP0
    s_setprio 0
SWP0:
    s_branch F_1
F_SW1:
    s_bitset1_b32 s56, 1
    s_add_u32 s57, s57, 1
    s_cmp_eq_u32 s57, 6
    s_cbranch_scc1 X_F0
    v_readlane_b32 s52, v61, s57
    s_and_b32 s51, s57, 1
    s_cselect_b32 s4, 0, -1
    s_mov_b32 s5, s4
    s_lshl_b32 s51, s51, 5
    v_cndmask_b32 v4, v4, v59, s[4:5]
    v_cndmask_b32 v59, v59, v60, s[4:5]
    s_add_u32 s52, s52, s51
    s_cmp_lt_u32 s57, 3
    s_cbranch_scc1 SWP1
    s_setprio 2
    s_cmp_lt_u32 s57, 4
    s_cbranch_scc1 SWP1
    s_setprio 1
    s_cmp_lt_u32 s57, 5
    s_cbranch_scc1 SWP1
    s_setprio 0
SWP1:
    s_branch F_2
F_SW2:
    s_bitset1_b32 s56, 2
    s_add_u32 s57, s57, 1
    s_cmp_eq_u32 s57, 6
    s_cbranch_scc1 X_F0
    v_readlane_b32 s52, v61, s57
    s_and_b32 s51, s57, 1
    s_cselect_b32 s4, 0, -1
    s_mov_b32 s5, s4
    s_lshl_b32 s51, s51, 5
    v_cndmask_b32 v4, v4, v59, s[4:5]
    v_cndmask_b32 v59, v59, v60, s[4:5]
    s_add_u32 s52, s52, s51
    s_cmp_lt_u32 s57, 3
    s_cbranch_scc1 SWP2
    s_setprio 2
    s_cmp_lt_u32 s57, 4
    s_cbranch_scc1 SWP2
    s_setprio 1
    s_cmp_lt_u32 s57, 5
    s_cbranch_scc1 SWP2
    s_setprio 0
SWP2:
    s_branch F_3
F_SW3:
    s_bitset1_b32 s56, 3
    s_add_u32 s57, s57, 1
    s_cmp_eq_u32 s57, 6
    s_cbranch_scc1 X_F0
    v_readlane_b32 s52, v61, s57
    s_and_b32 s51, s57, 1
    s_cselect_b32 s4, 0, -1
    s_mov_b32 s5, s4
    s_lshl_b32 s51, s51, 5
    v_cndmask_b32 v4, v4, v59, s[4:5]
    v_cndmask_b32 v59, v59, v60, s[4:5]
    s_add_u32 s52, s52, s51
    s_cmp_lt_u32 s57, 3
    s_cbranch_scc1 SWP3
    s_setprio 2
    s_cmp_lt_u32 s57, 4
    s_cbranch_scc1 SWP3
    s_setprio 1
    s_cmp_lt_u32 s57, 5
    s_cbranch_scc1 SWP3
    s_setprio 0
SWP3:
    s_branch F_4
F_SW4:
    s_bitset1_b32 s56, 4
    s_add_u32 s57, s57, 1
    s_cmp_eq_u32 s57, 6
    s_cbranch_scc1 X_F0
    v_readlane_b32 s52, v61, s57
    s_and_b32 s51, s57, 1
    s_cselect_b32 s4, 0, -1
    s_mov_b32 s5, s4
    s_lshl_b32 s51, s51, 5
    v_cndmask_b32 v4, v4, v59, s[4:5]
    v_cndmask_b32 v59, v59, v60, s[4:5]
    s_add_u32 s52, s52, s51
    s_cmp_lt_u32 s57, 3
    s_cbranch_scc1 SWP4
    s_setprio 2
    s_cmp_lt_u32 s57, 4
    s_cbranch_scc1 SWP4
    s_setprio 1
    s_cmp_lt_u32 s57, 5
    s_cbranch_scc1 SWP4
    s_setprio 0
SWP4:
    s_branch F_5
F_SW5:
    s_bitset1_b32 s56, 5
    s_add_u32 s57, s57, 1
    s_cmp_eq_u32 s57, 6
    s_cbranch_scc1 X_F0
    v_readlane_b32 s52, v61, s57
    s_and_b32 s51, s57, 1
    s_cselect_b32 s4, 0, -1
    s_mov_b32 s5, s4
    s_lshl_b32 s51, s51, 5
    v_cndmask_b32 v4, v4, v59, s[4:5]
    v_cndmask_b32 v59, v59, v60, s[4:5]
    s_add_u32 s52, s52, s51
    s_cmp_lt_u32 s57, 3
    s_cbranch_scc1 SWP5
    s_setprio 2
    s_cmp_lt_u32 s57, 4
    s_cbranch_scc1 SWP5
    s_setprio 1
    s_cmp_lt_u32 s57, 5
    s_cbranch_scc1 SWP5
    s_setprio 0
SWP5:
    s_branch F_6
F_SW6:
    s_bitset1_b32 s56, 6
    s_add_u32 s57, s57, 1
    s_cmp_eq_u32 s57, 6
    s_cbranch_scc1 X_F0
    v_readlane_b32 s52, v61, s57
    s_and_b32 s51, s57, 1
    s_cselect_b32 s4, 0, -1
    s_mov_b32 s5, s4
    s_lshl_b32 s51, s51, 5
    v_cndmask_b32 v4, v4, v59, s[4:5]
    v_cndmask_b32 v59, v59, v60, s[4:5]
    s_add_u32 s52, s52, s51
    s_cmp_lt_u32 s57, 3
    s_cbranch_scc1 SWP6
    s_setprio 2
    s_cmp_lt_u32 s57, 4
    s_cbranch_scc1 SWP6
    s_setprio 1
    s_cmp_lt_u32 s57, 5
    s_cbranch_scc1 SWP6
    s_setprio 0
SWP6:
    s_branch F_7
F_SW7:
    s_bitset1_b32 s56, 7
    s_add_u32 s57, s57, 1
    s_cmp_eq_u32 s57, 6
    s_cbranch_scc1 X_F0
    v_readlane_b32 s52, v61, s57
    s_and_b32 s51, s57, 1
    s_cselect_b32 s4, 0, -1
    s_mov_b32 s5, s4
    s_lshl_b32 s51, s51, 5
    v_cndmask_b32 v4, v4, v59, s[4:5]
    v_cndmask_b32 v59, v59, v60, s[4:5]
    s_add_u32 s52, s52, s51
    s_cmp_lt_u32 s57, 3
    s_cbranch_scc1 SWP7
    s_setprio 2
    s_cmp_lt_u32 s57, 4
    s_cbranch_scc1 SWP7
    s_setprio 1
    s_cmp_lt_u32 s57, 5
    s_cbranch_scc1 SWP7
    s_setprio 0
SWP7:
    s_branch G_F0
G_N0:
    s_waitcnt vmcnt(7)
    v_readlane_b32 s55, v4, s51
    v_mfma_f32_16x16x32_bf16 v[10:13], v[48:51], v[16:19], v[10:13]
G_C0:
    s_add_u32 s51, s51, 1
    s_bitcmp1_b32 s56, 0
    v_bfe_u32 v7, s55, v3, 16
    v_lshl_add_u32 v7, v7, 9, v2
    buffer_load_dwordx4 v[16:19], v7, s[8:11], 0 offen
    s_cbranch_scc1 G_FL0
    s_cmp_eq_u32 s51, s52
    s_cbranch_scc1 G_SN0
G_N1:
    s_waitcnt vmcnt(7)
    v_readlane_b32 s55, v4, s51
    v_mfma_f32_16x16x32_bf16 v[10:13], v[48:51], v[20:23], v[10:13]
G_C1:
    s_add_u32 s51, s51, 1
    s_bitcmp1_b32 s56, 1
    v_bfe_u32 v7, s55, v3, 16
    v_lshl_add_u32 v7, v7, 9, v2
    buffer_load_dwordx4 v[20:23], v7, s[8:11], 0 offen
    s_cbranch_scc1 G_FL1
    s_cmp_eq_u32 s51, s52
    s_cbranch_scc1 G_SN1
G_N2:
    s_waitcnt vmcnt(7)
    v_readlane_b32 s55, v4, s51
    v_mfma_f32_16x16x32_bf16 v[10:13], v[48:51], v[24:27], v[10:13]
G_C2:
    s_add_u32 s51, s51, 1
    s_bitcmp1_b32 s56, 2
    v_bfe_u32 v7, s55, v3, 16
    v_lshl_add_u32 v7, v7, 9, v2
    buffer_load_dwordx4 v[24:27], v7, s[8:11], 0 offen
    s_cbranch_scc1 G_FL2
    s_cmp_eq_u32 s51, s52
    s_cbranch_scc1 G_SN2
G_N3:
    s_waitcnt vmcnt(7)
    v_readlane_b32 s55, v4, s51
    v_mfma_f32_16x16x32_bf16 v[10:13], v[48:51], v[28:31], v[10:13]
G_C3:
    s_add_u32 s51, s51, 1
    s_bitcmp1_b32 s56, 3
    v_bfe_u32 v7, s55, v3, 16
    v_lshl_add_u32 v7, v7, 9, v2
    buffer_load_dwordx4 v[28:31], v7, s[8:11], 0 offen
    s_cbranch_scc1 G_FL3
    s_cmp_eq_u32 s51, s52
    s_cbranch_scc1 G_SN3
G_N4:
    s_waitcnt vmcnt(7)
    v_readlane_b32 s55, v4, s51
    v_mfma_f32_16x16x32_bf16 v[10:13], v[48:51], v[32:35], v[10:13]
G_C4:
    s_add_u32 s51, s51, 1
    s_bitcmp1_b32 s56, 4
    v_bfe_u32 v7, s55, v3, 16
    v_lshl_add_u32 v7, v7, 9, v2
    buffer_load_dwordx4 v[32:35], v7, s[8:11], 0 offen
    s_cbranch_scc1 G_FL4
    s_cmp_eq_u32 s51, s52
    s_cbranch_scc1 G_SN4
G_N5:
    s_waitcnt vmcnt(7)
    v_readlane_b32 s55, v4, s51
    v_mfma_f32_16x16x32_bf16 v[10:13], v[48:51], v[36:39], v[10:13]
G_C5:
    s_add_u32 s51, s51, 1
    s_bitcmp1_b32 s56, 5
    v_bfe_u32 v7, s55, v3, 16
    v_lshl_add_u32 v7, v7, 9, v2
    buffer_load_dwordx4 v[36:39], v7, s[8:11], 0 offen
    s_cbranch_scc1 G_FL5
    s_cmp_eq_u32 s51, s52
    s_cbranch_scc1 G_SN5
G_N6:
    s_waitcnt vmcnt(7)
    v_readlane_b32 s55, v4, s51
    v_mfma_f32_16x16x32_bf16 v[10:13], v[48:51], v[40:43], v[10:13]
G_C6:
    s_add_u32 s51, s51, 1
    s_bitcmp1_b32 s56, 6
    v_bfe_u32 v7, s55, v3, 16
    v_lshl_add_u32 v7, v7, 9, v2
    buffer_load_dwordx4 v[40:43], v7, s[8:11], 0 offen
    s_cbranch_scc1 G_FL6
    s_cmp_eq_u32 s51, s52
    s_cbranch_scc1 G_SN6
G_N7:
    s_waitcnt vmcnt(7)
    v_readlane_b32 s55, v4, s51
    v_mfma_f32_16x16x32_bf16 v[10:13], v[48:51], v[44:47], v[10:13]
G_C7:
    s_add_u32 s51, s51, 1
    s_bitcmp1_b32 s56, 7
    v_bfe_u32 v7, s55, v3, 16
    v_lshl_add_u32 v7, v7, 9, v2
    buffer_load_dwordx4 v[44:47], v7, s[8:11], 0 offen
    s_cbranch_scc1 G_FL7
    s_cmp_eq_u32 s51, s52
    s_cbranch_scc1 G_SN7
    s_branch G_N0
G_SN0:
    s_bitset1_b32 s56, 0
    s_add_u32 s57, s57, 1
    s_cmp_eq_u32 s57, 6
    s_cbranch_scc1 X_N1
    v_readlane_b32 s52, v61, s57
    s_and_b32 s51, s57, 1
    s_cselect_b32 s4, 0, -1
    s_mov_b32 s5, s4
    s_lshl_b32 s51, s51, 5
    v_cndmask_b32 v4, v4, v59, s[4:5]
    v_cndmask_b32 v59, v59, v60, s[4:5]
    s_add_u32 s52, s52, s51
    s_cmp_lt_u32 s57, 3
    s_cbranch_scc1 SWP8
    s_setprio 2
    s_cmp_lt_u32 s57, 4
    s_cbranch_scc1 SWP8
    s_setprio 1
    s_cmp_lt_u32 s57, 5
    s_cbranch_scc1 SWP8
    s_setprio 0
SWP8:
    s_branch G_N1
G_SN1:
    s_bitset1_b32 s56, 1
    s_add_u32 s57, s57, 1
    s_cmp_eq_u32 s57, 6
    s_cbranch_scc1 X_N2
    v_readlane_b32 s52, v61, s57
    s_and_b32 s51, s57, 1
    s_cselect_b32 s4, 0, -1
    s_mov_b32 s5, s4
    s_lshl_b32 s51, s51, 5
    v_cndmask_b32 v4, v4, v59, s[4:5]
    v_cndmask_b32 v59, v59, v60, s[4:5]
    s_add_u32 s52, s52, s51
    s_cmp_lt_u32 s57, 3
    s_cbranch_scc1 SWP9
    s_setprio 2
    s_cmp_lt_u32 s57, 4
    s_cbranch_scc1 SWP9
    s_setprio 1
    s_cmp_lt_u32 s57, 5
    s_cbranch_scc1 SWP9
    s_setprio 0
SWP9:
    s_branch G_N2
G_SN2:
    s_bitset1_b32 s56, 2
    s_add_u32 s57, s57, 1
    s_cmp_eq_u32 s57, 6
    s_cbranch_scc1 X_N3
    v_readlane_b32 s52, v61, s57
    s_and_b32 s51, s57, 1
    s_cselect_b32 s4, 0, -1
    s_mov_b32 s5, s4
    s_lshl_b32 s51, s51, 5
    v_cndmask_b32 v4, v4, v59, s[4:5]
    v_cndmask_b32 v59, v59, v60, s[4:5]
    s_add_u32 s52, s52, s51
    s_cmp_lt_u32 s57, 3
    s_cbranch_scc1 SWP10
    s_setprio 2
    s_cmp_lt_u32 s57, 4
    s_cbranch_scc1 SWP10
    s_setprio 1
    s_cmp_lt_u32 s57, 5
    s_cbranch_scc1 SWP10
    s_setprio 0
SWP10:
    s_branch G_N3
G_SN3:
    s_bitset1_b32 s56, 3
    s_add_u32 s57, s57, 1
    s_cmp_eq_u32 s57, 6
    s_cbranch_scc1 X_N4
    v_readlane_b32 s52, v61, s57
    s_and_b32 s51, s57, 1
    s_cselect_b32 s4, 0, -1
    s_mov_b32 s5, s4
    s_lshl_b32 s51, s51, 5
    v_cndmask_b32 v4, v4, v59, s[4:5]
    v_cndmask_b32 v59, v59, v60, s[4:5]
    s_add_u32 s52, s52, s51
    s_cmp_lt_u32 s57, 3
    s_cbranch_scc1 SWP11
    s_setprio 2
    s_cmp_lt_u32 s57, 4
    s_cbranch_scc1 SWP11
    s_setprio 1
    s_cmp_lt_u32 s57, 5
    s_cbranch_scc1 SWP11
    s_setprio 0
SWP11:
    s_branch G_N4
G_SN4:
    s_bitset1_b32 s56, 4
    s_add_u32 s57, s57, 1
    s_cmp_eq_u32 s57, 6
    s_cbranch_scc1 X_N5
    v_readlane_b32 s52, v61, s57
    s_and_b32 s51, s57, 1
    s_cselect_b32 s4, 0, -1
    s_mov_b32 s5, s4
    s_lshl_b32 s51, s51, 5
    v_cndmask_b32 v4, v4, v59, s[4:5]
    v_cndmask_b32 v59, v59, v60, s[4:5]
    s_add_u32 s52, s52, s51
    s_cmp_lt_u32 s57, 3
    s_cbranch_scc1 SWP12
    s_setprio 2
    s_cmp_lt_u32 s57, 4
    s_cbranch_scc1 SWP12
    s_setprio 1
    s_cmp_lt_u32 s57, 5
    s_cbranch_scc1 SWP12
    s_setprio 0
SWP12:
    s_branch G_N5
G_SN5:
    s_bitset1_b32 s56, 5
    s_add_u32 s57, s57, 1
    s_cmp_eq_u32 s57, 6
    s_cbranch_scc1 X_N6
    v_readlane_b32 s52, v61, s57
    s_and_b32 s51, s57, 1
    s_cselect_b32 s4, 0, -1
    s_mov_b32 s5, s4
    s_lshl_b32 s51, s51, 5
    v_cndmask_b32 v4, v4, v59, s[4:5]
    v_cndmask_b32 v59, v59, v60, s[4:5]
    s_add_u32 s52, s52, s51
    s_cmp_lt_u32 s57, 3
    s_cbranch_scc1 SWP13
    s_setprio 2
    s_cmp_lt_u32 s57, 4
    s_cbranch_scc1 SWP13
    s_setprio 1
    s_cmp_lt_u32 s57, 5
    s_cbranch_scc1 SWP13
    s_setprio 0
SWP13:
    s_branch G_N6
G_SN6:
    s_bitset1_b32 s56, 6
    s_add_u32 s57, s57, 1
    s_cmp_eq_u32 s57, 6
    s_cbranch_scc1 X_N7
    v_readlane_b32 s52, v61, s57
    s_and_b32 s51, s57, 1
    s_cselect_b32 s4, 0, -1
    s_mov_b32 s5, s4
    s_lshl_b32 s51, s51, 5
    v_cndmask_b32 v4, v4, v59, s[4:5]
    v_cndmask_b32 v59, v59, v60, s[4:5]
    s_add_u32 s52, s52, s51
    s_cmp_lt_u32 s57, 3
    s_cbranch_scc1 SWP14
    s_setprio 2
    s_cmp_lt_u32 s57, 4
    s_cbranch_scc1 SWP14
    s_setprio 1
    s_cmp_lt_u32 s57, 5
    s_cbranch_scc1 SWP14
    s_setprio 0
SWP14:
    s_branch G_N7
G_SN7:
    s_bitset1_b32 s56, 7
    s_add_u32 s57, s57, 1
    s_cmp_eq_u32 s57, 6
    s_cbranch_scc1 X_N0
    v_readlane_b32 s52, v61, s57
    s_and_b32 s51, s57, 1
    s_cselect_b32 s4, 0, -1
    s_mov_b32 s5, s4
    s_lshl_b32 s51, s51, 5
    v_cndmask_b32 v4, v4, v59, s[4:5]
    v_cndmask_b32 v59, v59, v60, s[4:5]
    s_add_u32 s52, s52, s51
    s_cmp_lt_u32 s57, 3
    s_cbranch_scc1 SWP15
    s_setprio 2
    s_cmp_lt_u32 s57, 4
    s_cbranch_scc1 SWP15
    s_setprio 1
    s_cmp_lt_u32 s57, 5
    s_cbranch_scc1 SWP15
    s_setprio 0
SWP15:
    s_branch G_N0
G_FL0:
    s_bitset0_b32 s56, 0
    s_sub_u32 s50, s50, 1
    s_nop 0
    v_xor_b32 v5, s53, v8
    v_cvt_pk_bf16_f32 v14, v10, v11
    v_cvt_pk_bf16_f32 v15, v12, v13
    ds_write_b64 v5, v[14:15] offset:0
    s_and_b32 s4, s54, 1
    s_cselect_b64 s[6:7], -1, 0
    v_swap_b32 v52, v124
    v_swap_b32 v53, v125
    v_swap_b32 v54, v126
    v_swap_b32 v55, v127
    v_cndmask_b32 v112, v112, v116, s[6:7]
    v_cndmask_b32 v113, v113, v117, s[6:7]
    v_cndmask_b32 v114, v114, v118, s[6:7]
    v_cndmask_b32 v115, v115, v119, s[6:7]
    v_cndmask_b32 v116, v116, v120, s[6:7]
    v_cndmask_b32 v117, v117, v121, s[6:7]
    v_cndmask_b32 v118, v118, v122, s[6:7]
    v_cndmask_b32 v119, v119, v123, s[6:7]
    s_mul_i32 s4, s4, 14
    s_add_u32 s54, s54, s4
    s_add_u32 s54, s54, 1
    s_lshl_b32 s53, s54, 9
    s_and_b32 s44, s54, 15
    s_lshl_b32 s44, s44, 4
    s_or_b32 s53, s53, s44
    s_cmp_eq_u32 s51, s52
    s_cbranch_scc0 G_F1
    s_bitset1_b32 s56, 0
    s_add_u32 s57, s57, 1
    s_cmp_eq_u32 s57, 6
    s_cbranch_scc1 X_F1
    v_readlane_b32 s52, v61, s57
    s_and_b32 s51, s57, 1
    s_cselect_b32 s4, 0, -1
    s_mov_b32 s5, s4
    s_lshl_b32 s51, s51, 5
    v_cndmask_b32 v4, v4, v59, s[4:5]
    v_cndmask_b32 v59, v59, v60, s[4:5]
    s_add_u32 s52, s52, s51
    s_cmp_lt_u32 s57, 3
    s_cbranch_scc1 SWP16
    s_setprio 2
    s_cmp_lt_u32 s57, 4
    s_cbranch_scc1 SWP16
    s_setprio 1
    s_cmp_lt_u32 s57, 5
    s_cbranch_scc1 SWP16
    s_setprio 0
SWP16:
G_F1:
    s_waitcnt vmcnt(7)
    v_readlane_b32 s55, v4, s51
    v_mfma_f32_16x16x32_bf16 v[10:13], v[52:55], v[112:115], 0
    v_mfma_f32_16x16x32_bf16 v[10:13], v[48:51], v[20:23], v[10:13]
    s_branch G_C1
G_FL1:
    s_bitset0_b32 s56, 1
    s_sub_u32 s50, s50, 1
    s_nop 0
    v_xor_b32 v5, s53, v8
    v_cvt_pk_bf16_f32 v14, v10, v11
    v_cvt_pk_bf16_f32 v15, v12, v13
    ds_write_b64 v5, v[14:15] offset:0
    s_and_b32 s4, s54, 1
    s_cselect_b64 s[6:7], -1, 0
    v_swap_b32 v52, v124
    v_swap_b32 v53, v125
    v_swap_b32 v54, v126
    v_swap_b32 v55, v127
    v_cndmask_b32 v112, v112, v116, s[6:7]
    v_cndmask_b32 v113, v113, v117, s[6:7]
    v_cndmask_b32 v114, v114, v118, s[6:7]
    v_cndmask_b32 v115, v115, v119, s[6:7]
    v_cndmask_b32 v116, v116, v120, s[6:7]
    v_cndmask_b32 v117, v117, v121, s[6:7]
    v_cndmask_b32 v118, v118, v122, s[6:7]
    v_cndmask_b32 v119, v119, v123, s[6:7]
    s_mul_i32 s4, s4, 14
    s_add_u32 s54, s54, s4
    s_add_u32 s54, s54, 1
    s_lshl_b32 s53, s54, 9
    s_and_b32 s44, s54, 15
    s_lshl_b32 s44, s44, 4
    s_or_b32 s53, s53, s44
    s_cmp_eq_u32 s51, s52
    s_cbranch_scc0 G_F2
    s_bitset1_b32 s56, 1
    s_add_u32 s57, s57, 1
    s_cmp_eq_u32 s57, 6
    s_cbranch_scc1 X_F2
    v_readlane_b32 s52, v61, s57
    s_and_b32 s51, s57, 1
    s_cselect_b32 s4, 0, -1
    s_mov_b32 s5, s4
    s_lshl_b32 s51, s51, 5
    v_cndmask_b32 v4, v4, v59, s[4:5]
    v_cndmask_b32 v59, v59, v60, s[4:5]
    s_add_u32 s52, s52, s51
    s_cmp_lt_u32 s57, 3
    s_cbranch_scc1 SWP17
    s_setprio 2
    s_cmp_lt_u32 s57, 4
    s_cbranch_scc1 SWP17
    s_setprio 1
    s_cmp_lt_u32 s57, 5
    s_cbranch_scc1 SWP17
    s_setprio 0
SWP17:
G_F2:
    s_waitcnt vmcnt(7)
    v_readlane_b32 s55, v4, s51
    v_mfma_f32_16x16x32_bf16 v[10:13], v[52:55], v[112:115], 0
    v_mfma_f32_16x16x32_bf16 v[10:13], v[48:51], v[24:27], v[10:13]
    s_branch G_C2
G_FL2:
    s_bitset0_b32 s56, 2
    s_sub_u32 s50, s50, 1
    s_nop 0
    v_xor_b32 v5, s53, v8
    v_cvt_pk_bf16_f32 v14, v10, v11
    v_cvt_pk_bf16_f32 v15, v12, v13
    ds_write_b64 v5, v[14:15] offset:0
    s_and_b32 s4, s54, 1
    s_cselect_b64 s[6:7], -1, 0
    v_swap_b32 v52, v124
    v_swap_b32 v53, v125
    v_swap_b32 v54, v126
    v_swap_b32 v55, v127
    v_cndmask_b32 v112, v112, v116, s[6:7]
    v_cndmask_b32 v113, v113, v117, s[6:7]
    v_cndmask_b32 v114, v114, v118, s[6:7]
    v_cndmask_b32 v115, v115, v119, s[6:7]
    v_cndmask_b32 v116, v116, v120, s[6:7]
    v_cndmask_b32 v117, v117, v121, s[6:7]
    v_cndmask_b32 v118, v118, v122, s[6:7]
    v_cndmask_b32 v119, v119, v123, s[6:7]
    s_mul_i32 s4, s4, 14
    s_add_u32 s54, s54, s4
    s_add_u32 s54, s54, 1
    s_lshl_b32 s53, s54, 9
    s_and_b32 s44, s54, 15
    s_lshl_b32 s44, s44, 4
    s_or_b32 s53, s53, s44
    s_cmp_eq_u32 s51, s52
    s_cbranch_scc0 G_F3
    s_bitset1_b32 s56, 2
    s_add_u32 s57, s57, 1
    s_cmp_eq_u32 s57, 6
    s_cbranch_scc1 X_F3
    v_readlane_b32 s52, v61, s57
    s_and_b32 s51, s57, 1
    s_cselect_b32 s4, 0, -1
    s_mov_b32 s5, s4
    s_lshl_b32 s51, s51, 5
    v_cndmask_b32 v4, v4, v59, s[4:5]
    v_cndmask_b32 v59, v59, v60, s[4:5]
    s_add_u32 s52, s52, s51
    s_cmp_lt_u32 s57, 3
    s_cbranch_scc1 SWP18
    s_setprio 2
    s_cmp_lt_u32 s57, 4
    s_cbranch_scc1 SWP18
    s_setprio 1
    s_cmp_lt_u32 s57, 5
    s_cbranch_scc1 SWP18
    s_setprio 0
SWP18:
G_F3:
    s_waitcnt vmcnt(7)
    v_readlane_b32 s55, v4, s51
    v_mfma_f32_16x16x32_bf16 v[10:13], v[52:55], v[112:115], 0
    v_mfma_f32_16x16x32_bf16 v[10:13], v[48:51], v[28:31], v[10:13]
    s_branch G_C3
G_FL3:
    s_bitset0_b32 s56, 3
    s_sub_u32 s50, s50, 1
    s_nop 0
    v_xor_b32 v5, s53, v8
    v_cvt_pk_bf16_f32 v14, v10, v11
    v_cvt_pk_bf16_f32 v15, v12, v13
    ds_write_b64 v5, v[14:15] offset:0
    s_and_b32 s4, s54, 1
    s_cselect_b64 s[6:7], -1, 0
    v_swap_b32 v52, v124
    v_swap_b32 v53, v125
    v_swap_b32 v54, v126
    v_swap_b32 v55, v127
    v_cndmask_b32 v112, v112, v116, s[6:7]
    v_cndmask_b32 v113, v113, v117, s[6:7]
    v_cndmask_b32 v114, v114, v118, s[6:7]
    v_cndmask_b32 v115, v115, v119, s[6:7]
    v_cndmask_b32 v116, v116, v120, s[6:7]
    v_cndmask_b32 v117, v117, v121, s[6:7]
    v_cndmask_b32 v118, v118, v122, s[6:7]
    v_cndmask_b32 v119, v119, v123, s[6:7]
    s_mul_i32 s4, s4, 14
    s_add_u32 s54, s54, s4
    s_add_u32 s54, s54, 1
    s_lshl_b32 s53, s54, 9
    s_and_b32 s44, s54, 15
    s_lshl_b32 s44, s44, 4
    s_or_b32 s53, s53, s44
    s_cmp_eq_u32 s51, s52
    s_cbranch_scc0 G_F4
    s_bitset1_b32 s56, 3
    s_add_u32 s57, s57, 1
    s_cmp_eq_u32 s57, 6
    s_cbranch_scc1 X_F4
    v_readlane_b32 s52, v61, s57
    s_and_b32 s51, s57, 1
    s_cselect_b32 s4, 0, -1
    s_mov_b32 s5, s4
    s_lshl_b32 s51, s51, 5
    v_cndmask_b32 v4, v4, v59, s[4:5]
    v_cndmask_b32 v59, v59, v60, s[4:5]
    s_add_u32 s52, s52, s51
    s_cmp_lt_u32 s57, 3
    s_cbranch_scc1 SWP19
    s_setprio 2
    s_cmp_lt_u32 s57, 4
    s_cbranch_scc1 SWP19
    s_setprio 1
    s_cmp_lt_u32 s57, 5
    s_cbranch_scc1 SWP19
    s_setprio 0
SWP19:
G_F4:
    s_waitcnt vmcnt(7)
    v_readlane_b32 s55, v4, s51
    v_mfma_f32_16x16x32_bf16 v[10:13], v[52:55], v[112:115], 0
    v_mfma_f32_16x16x32_bf16 v[10:13], v[48:51], v[32:35], v[10:13]
    s_branch G_C4
G_FL4:
    s_bitset0_b32 s56, 4
    s_sub_u32 s50, s50, 1
    s_nop 0
    v_xor_b32 v5, s53, v8
    v_cvt_pk_bf16_f32 v14, v10, v11
    v_cvt_pk_bf16_f32 v15, v12, v13
    ds_write_b64 v5, v[14:15] offset:0
    s_and_b32 s4, s54, 1
    s_cselect_b64 s[6:7], -1, 0
    v_swap_b32 v52, v124
    v_swap_b32 v53, v125
    v_swap_b32 v54, v126
    v_swap_b32 v55, v127
    v_cndmask_b32 v112, v112, v116, s[6:7]
    v_cndmask_b32 v113, v113, v117, s[6:7]
    v_cndmask_b32 v114, v114, v118, s[6:7]
    v_cndmask_b32 v115, v115, v119, s[6:7]
    v_cndmask_b32 v116, v116, v120, s[6:7]
    v_cndmask_b32 v117, v117, v121, s[6:7]
    v_cndmask_b32 v118, v118, v122, s[6:7]
    v_cndmask_b32 v119, v119, v123, s[6:7]
    s_mul_i32 s4, s4, 14
    s_add_u32 s54, s54, s4
    s_add_u32 s54, s54, 1
    s_lshl_b32 s53, s54, 9
    s_and_b32 s44, s54, 15
    s_lshl_b32 s44, s44, 4
    s_or_b32 s53, s53, s44
    s_cmp_eq_u32 s51, s52
    s_cbranch_scc0 G_F5
    s_bitset1_b32 s56, 4
    s_add_u32 s57, s57, 1
    s_cmp_eq_u32 s57, 6
    s_cbranch_scc1 X_F5
    v_readlane_b32 s52, v61, s57
    s_and_b32 s51, s57, 1
    s_cselect_b32 s4, 0, -1
    s_mov_b32 s5, s4
    s_lshl_b32 s51, s51, 5
    v_cndmask_b32 v4, v4, v59, s[4:5]
    v_cndmask_b32 v59, v59, v60, s[4:5]
    s_add_u32 s52, s52, s51
    s_cmp_lt_u32 s57, 3
    s_cbranch_scc1 SWP20
    s_setprio 2
    s_cmp_lt_u32 s57, 4
    s_cbranch_scc1 SWP20
    s_setprio 1
    s_cmp_lt_u32 s57, 5
    s_cbranch_scc1 SWP20
    s_setprio 0
SWP20:
G_F5:
    s_waitcnt vmcnt(7)
    v_readlane_b32 s55, v4, s51
    v_mfma_f32_16x16x32_bf16 v[10:13], v[52:55], v[112:115], 0
    v_mfma_f32_16x16x32_bf16 v[10:13], v[48:51], v[36:39], v[10:13]
    s_branch G_C5
G_FL5:
    s_bitset0_b32 s56, 5
    s_sub_u32 s50, s50, 1
    s_nop 0
    v_xor_b32 v5, s53, v8
    v_cvt_pk_bf16_f32 v14, v10, v11
    v_cvt_pk_bf16_f32 v15, v12, v13
    ds_write_b64 v5, v[14:15] offset:0
    s_and_b32 s4, s54, 1
    s_cselect_b64 s[6:7], -1, 0
    v_swap_b32 v52, v124
    v_swap_b32 v53, v125
    v_swap_b32 v54, v126
    v_swap_b32 v55, v127
    v_cndmask_b32 v112, v112, v116, s[6:7]
    v_cndmask_b32 v113, v113, v117, s[6:7]
    v_cndmask_b32 v114, v114, v118, s[6:7]
    v_cndmask_b32 v115, v115, v119, s[6:7]
    v_cndmask_b32 v116, v116, v120, s[6:7]
    v_cndmask_b32 v117, v117, v121, s[6:7]
    v_cndmask_b32 v118, v118, v122, s[6:7]
    v_cndmask_b32 v119, v119, v123, s[6:7]
    s_mul_i32 s4, s4, 14
    s_add_u32 s54, s54, s4
    s_add_u32 s54, s54, 1
    s_lshl_b32 s53, s54, 9
    s_and_b32 s44, s54, 15
    s_lshl_b32 s44, s44, 4
    s_or_b32 s53, s53, s44
    s_cmp_eq_u32 s51, s52
    s_cbranch_scc0 G_F6
    s_bitset1_b32 s56, 5
    s_add_u32 s57, s57, 1
    s_cmp_eq_u32 s57, 6
    s_cbranch_scc1 X_F6
    v_readlane_b32 s52, v61, s57
    s_and_b32 s51, s57, 1
    s_cselect_b32 s4, 0, -1
    s_mov_b32 s5, s4
    s_lshl_b32 s51, s51, 5
    v_cndmask_b32 v4, v4, v59, s[4:5]
    v_cndmask_b32 v59, v59, v60, s[4:5]
    s_add_u32 s52, s52, s51
    s_cmp_lt_u32 s57, 3
    s_cbranch_scc1 SWP21
    s_setprio 2
    s_cmp_lt_u32 s57, 4
    s_cbranch_scc1 SWP21
    s_setprio 1
    s_cmp_lt_u32 s57, 5
    s_cbranch_scc1 SWP21
    s_setprio 0
SWP21:
G_F6:
    s_waitcnt vmcnt(7)
    v_readlane_b32 s55, v4, s51
    v_mfma_f32_16x16x32_bf16 v[10:13], v[52:55], v[112:115], 0
    v_mfma_f32_16x16x32_bf16 v[10:13], v[48:51], v[40:43], v[10:13]
    s_branch G_C6
G_FL6:
    s_bitset0_b32 s56, 6
    s_sub_u32 s50, s50, 1
    s_nop 0
    v_xor_b32 v5, s53, v8
    v_cvt_pk_bf16_f32 v14, v10, v11
    v_cvt_pk_bf16_f32 v15, v12, v13
    ds_write_b64 v5, v[14:15] offset:0
    s_and_b32 s4, s54, 1
    s_cselect_b64 s[6:7], -1, 0
    v_swap_b32 v52, v124
    v_swap_b32 v53, v125
    v_swap_b32 v54, v126
    v_swap_b32 v55, v127
    v_cndmask_b32 v112, v112, v116, s[6:7]
    v_cndmask_b32 v113, v113, v117, s[6:7]
    v_cndmask_b32 v114, v114, v118, s[6:7]
    v_cndmask_b32 v115, v115, v119, s[6:7]
    v_cndmask_b32 v116, v116, v120, s[6:7]
    v_cndmask_b32 v117, v117, v121, s[6:7]
    v_cndmask_b32 v118, v118, v122, s[6:7]
    v_cndmask_b32 v119, v119, v123, s[6:7]
    s_mul_i32 s4, s4, 14
    s_add_u32 s54, s54, s4
    s_add_u32 s54, s54, 1
    s_lshl_b32 s53, s54, 9
    s_and_b32 s44, s54, 15
    s_lshl_b32 s44, s44, 4
    s_or_b32 s53, s53, s44
    s_cmp_eq_u32 s51, s52
    s_cbranch_scc0 G_F7
    s_bitset1_b32 s56, 6
    s_add_u32 s57, s57, 1
    s_cmp_eq_u32 s57, 6
    s_cbranch_scc1 X_F7
    v_readlane_b32 s52, v61, s57
    s_and_b32 s51, s57, 1
    s_cselect_b32 s4, 0, -1
    s_mov_b32 s5, s4
    s_lshl_b32 s51, s51, 5
    v_cndmask_b32 v4, v4, v59, s[4:5]
    v_cndmask_b32 v59, v59, v60, s[4:5]
    s_add_u32 s52, s52, s51
    s_cmp_lt_u32 s57, 3
    s_cbranch_scc1 SWP22
    s_setprio 2
    s_cmp_lt_u32 s57, 4
    s_cbranch_scc1 SWP22
    s_setprio 1
    s_cmp_lt_u32 s57, 5
    s_cbranch_scc1 SWP22
    s_setprio 0
SWP22:
G_F7:
    s_waitcnt vmcnt(7)
    v_readlane_b32 s55, v4, s51
    v_mfma_f32_16x16x32_bf16 v[10:13], v[52:55], v[112:115], 0
    v_mfma_f32_16x16x32_bf16 v[10:13], v[48:51], v[44:47], v[10:13]
    s_branch G_C7
G_FL7:
    s_bitset0_b32 s56, 7
    s_sub_u32 s50, s50, 1
    s_nop 0
    v_xor_b32 v5, s53, v8
    v_cvt_pk_bf16_f32 v14, v10, v11
    v_cvt_pk_bf16_f32 v15, v12, v13
    ds_write_b64 v5, v[14:15] offset:0
    s_and_b32 s4, s54, 1
    s_cselect_b64 s[6:7], -1, 0
    v_swap_b32 v52, v124
    v_swap_b32 v53, v125
    v_swap_b32 v54, v126
    v_swap_b32 v55, v127
    v_cndmask_b32 v112, v112, v116, s[6:7]
    v_cndmask_b32 v113, v113, v117, s[6:7]
    v_cndmask_b32 v114, v114, v118, s[6:7]
    v_cndmask_b32 v115, v115, v119, s[6:7]
    v_cndmask_b32 v116, v116, v120, s[6:7]
    v_cndmask_b32 v117, v117, v121, s[6:7]
    v_cndmask_b32 v118, v118, v122, s[6:7]
    v_cndmask_b32 v119, v119, v123, s[6:7]
    s_mul_i32 s4, s4, 14
    s_add_u32 s54, s54, s4
    s_add_u32 s54, s54, 1
    s_lshl_b32 s53, s54, 9
    s_and_b32 s44, s54, 15
    s_lshl_b32 s44, s44, 4
    s_or_b32 s53, s53, s44
    s_cmp_eq_u32 s51, s52
    s_cbranch_scc0 G_F0
    s_bitset1_b32 s56, 7
    s_add_u32 s57, s57, 1
    s_cmp_eq_u32 s57, 6
    s_cbranch_scc1 X_F0
    v_readlane_b32 s52, v61, s57
    s_and_b32 s51, s57, 1
    s_cselect_b32 s4, 0, -1
    s_mov_b32 s5, s4
    s_lshl_b32 s51, s51, 5
    v_cndmask_b32 v4, v4, v59, s[4:5]
    v_cndmask_b32 v59, v59, v60, s[4:5]
    s_add_u32 s52, s52, s51
    s_cmp_lt_u32 s57, 3
    s_cbranch_scc1 SWP23
    s_setprio 2
    s_cmp_lt_u32 s57, 4
    s_cbranch_scc1 SWP23
    s_setprio 1
    s_cmp_lt_u32 s57, 5
    s_cbranch_scc1 SWP23
    s_setprio 0
SWP23:
G_F0:
    s_waitcnt vmcnt(7)
    v_readlane_b32 s55, v4, s51
    v_mfma_f32_16x16x32_bf16 v[10:13], v[52:55], v[112:115], 0
    v_mfma_f32_16x16x32_bf16 v[10:13], v[48:51], v[16:19], v[10:13]
    s_branch G_C0
X_N0:
    s_waitcnt vmcnt(0)
    s_branch T_N0
X_F0:
    s_waitcnt vmcnt(0)
    s_branch T_F0
X_N1:
    s_waitcnt vmcnt(0)
    s_branch T_N1
X_F1:
    s_waitcnt vmcnt(0)
    s_branch T_F1
X_N2:
    s_waitcnt vmcnt(0)
    s_branch T_N2
X_F2:
    s_waitcnt vmcnt(0)
    s_branch T_F2
X_N3:
    s_waitcnt vmcnt(0)
    s_branch T_N3
X_F3:
    s_waitcnt vmcnt(0)
    s_branch T_F3
X_N4:
    s_waitcnt vmcnt(0)
    s_branch T_N4
X_F4:
    s_waitcnt vmcnt(0)
    s_branch T_F4
X_N5:
    s_waitcnt vmcnt(0)
    s_branch T_N5
X_F5:
    s_waitcnt vmcnt(0)
    s_branch T_F5
X_N6:
    s_waitcnt vmcnt(0)
    s_branch T_N6
X_F6:
    s_waitcnt vmcnt(0)
    s_branch T_F6
X_N7:
    s_waitcnt vmcnt(0)
    s_branch T_N7
X_F7:
    s_waitcnt vmcnt(0)
    s_branch T_F7
T_N0:
    v_mfma_f32_16x16x32_bf16 v[10:13], v[48:51], v[16:19], v[10:13]
T_C0:
    s_bitcmp1_b32 s56, 0
    s_cbranch_scc1 T_FL0
T_N1:
    v_mfma_f32_16x16x32_bf16 v[10:13], v[48:51], v[20:23], v[10:13]
T_C1:
    s_bitcmp1_b32 s56, 1
    s_cbranch_scc1 T_FL1
T_N2:
    v_mfma_f32_16x16x32_bf16 v[10:13], v[48:51], v[24:27], v[10:13]
T_C2:
    s_bitcmp1_b32 s56, 2
    s_cbranch_scc1 T_FL2
T_N3:
    v_mfma_f32_16x16x32_bf16 v[10:13], v[48:51], v[28:31], v[10:13]
T_C3:
    s_bitcmp1_b32 s56, 3
    s_cbranch_scc1 T_FL3
T_N4:
    v_mfma_f32_16x16x32_bf16 v[10:13], v[48:51], v[32:35], v[10:13]
T_C4:
    s_bitcmp1_b32 s56, 4
    s_cbranch_scc1 T_FL4
T_N5:
    v_mfma_f32_16x16x32_bf16 v[10:13], v[48:51], v[36:39], v[10:13]
T_C5:
    s_bitcmp1_b32 s56, 5
    s_cbranch_scc1 T_FL5
T_N6:
    v_mfma_f32_16x16x32_bf16 v[10:13], v[48:51], v[40:43], v[10:13]
T_C6:
    s_bitcmp1_b32 s56, 6
    s_cbranch_scc1 T_FL6
T_N7:
    v_mfma_f32_16x16x32_bf16 v[10:13], v[48:51], v[44:47], v[10:13]
T_C7:
    s_bitcmp1_b32 s56, 7
    s_cbranch_scc1 T_FL7
    s_cmp_eq_u32 s56, 0
    s_cbranch_scc1 M_GDONE
    s_branch T_N0
T_FL0:
    s_bitset0_b32 s56, 0
    s_sub_u32 s50, s50, 1
    s_nop 4
    v_xor_b32 v5, s53, v8
    v_cvt_pk_bf16_f32 v14, v10, v11
    v_cvt_pk_bf16_f32 v15, v12, v13
    ds_write_b64 v5, v[14:15] offset:0
    s_and_b32 s4, s54, 1
    s_cselect_b64 s[6:7], -1, 0
    v_swap_b32 v52, v124
    v_swap_b32 v53, v125
    v_swap_b32 v54, v126
    v_swap_b32 v55, v127
    v_cndmask_b32 v112, v112, v116, s[6:7]
    v_cndmask_b32 v113, v113, v117, s[6:7]
    v_cndmask_b32 v114, v114, v118, s[6:7]
    v_cndmask_b32 v115, v115, v119, s[6:7]
    v_cndmask_b32 v116, v116, v120, s[6:7]
    v_cndmask_b32 v117, v117, v121, s[6:7]
    v_cndmask_b32 v118, v118, v122, s[6:7]
    v_cndmask_b32 v119, v119, v123, s[6:7]
    s_mul_i32 s4, s4, 14
    s_add_u32 s54, s54, s4
    s_add_u32 s54, s54, 1
    s_lshl_b32 s53, s54, 9
    s_and_b32 s44, s54, 15
    s_lshl_b32 s44, s44, 4
    s_or_b32 s53, s53, s44
    s_cmp_eq_u32 s50, 0
    s_cbranch_scc1 M_GDONE
T_F1:
    v_mfma_f32_16x16x32_bf16 v[10:13], v[52:55], v[112:115], 0
    v_mfma_f32_16x16x32_bf16 v[10:13], v[48:51], v[20:23], v[10:13]
    s_branch T_C1
T_FL1:
    s_bitset0_b32 s56, 1
    s_sub_u32 s50, s50, 1
    s_nop 4
    v_xor_b32 v5, s53, v8
    v_cvt_pk_bf16_f32 v14, v10, v11
    v_cvt_pk_bf16_f32 v15, v12, v13
    ds_write_b64 v5, v[14:15] offset:0
    s_and_b32 s4, s54, 1
    s_cselect_b64 s[6:7], -1, 0
    v_swap_b32 v52, v124
    v_swap_b32 v53, v125
    v_swap_b32 v54, v126
    v_swap_b32 v55, v127
    v_cndmask_b32 v112, v112, v116, s[6:7]
    v_cndmask_b32 v113, v113, v117, s[6:7]
    v_cndmask_b32 v114, v114, v118, s[6:7]
    v_cndmask_b32 v115, v115, v119, s[6:7]
    v_cndmask_b32 v116, v116, v120, s[6:7]
    v_cndmask_b32 v117, v117, v121, s[6:7]
    v_cndmask_b32 v118, v118, v122, s[6:7]
    v_cndmask_b32 v119, v119, v123, s[6:7]
    s_mul_i32 s4, s4, 14
    s_add_u32 s54, s54, s4
    s_add_u32 s54, s54, 1
    s_lshl_b32 s53, s54, 9
    s_and_b32 s44, s54, 15
    s_lshl_b32 s44, s44, 4
    s_or_b32 s53, s53, s44
    s_cmp_eq_u32 s50, 0
    s_cbranch_scc1 M_GDONE
T_F2:
    v_mfma_f32_16x16x32_bf16 v[10:13], v[52:55], v[112:115], 0
    v_mfma_f32_16x16x32_bf16 v[10:13], v[48:51], v[24:27], v[10:13]
    s_branch T_C2
T_FL2:
    s_bitset0_b32 s56, 2
    s_sub_u32 s50, s50, 1
    s_nop 4
    v_xor_b32 v5, s53, v8
    v_cvt_pk_bf16_f32 v14, v10, v11
    v_cvt_pk_bf16_f32 v15, v12, v13
    ds_write_b64 v5, v[14:15] offset:0
    s_and_b32 s4, s54, 1
    s_cselect_b64 s[6:7], -1, 0
    v_swap_b32 v52, v124
    v_swap_b32 v53, v125
    v_swap_b32 v54, v126
    v_swap_b32 v55, v127
    v_cndmask_b32 v112, v112, v116, s[6:7]
    v_cndmask_b32 v113, v113, v117, s[6:7]
    v_cndmask_b32 v114, v114, v118, s[6:7]
    v_cndmask_b32 v115, v115, v119, s[6:7]
    v_cndmask_b32 v116, v116, v120, s[6:7]
    v_cndmask_b32 v117, v117, v121, s[6:7]
    v_cndmask_b32 v118, v118, v122, s[6:7]
    v_cndmask_b32 v119, v119, v123, s[6:7]
    s_mul_i32 s4, s4, 14
    s_add_u32 s54, s54, s4
    s_add_u32 s54, s54, 1
    s_lshl_b32 s53, s54, 9
    s_and_b32 s44, s54, 15
    s_lshl_b32 s44, s44, 4
    s_or_b32 s53, s53, s44
    s_cmp_eq_u32 s50, 0
    s_cbranch_scc1 M_GDONE
T_F3:
    v_mfma_f32_16x16x32_bf16 v[10:13], v[52:55], v[112:115], 0
    v_mfma_f32_16x16x32_bf16 v[10:13], v[48:51], v[28:31], v[10:13]
    s_branch T_C3
T_FL3:
    s_bitset0_b32 s56, 3
    s_sub_u32 s50, s50, 1
    s_nop 4
    v_xor_b32 v5, s53, v8
    v_cvt_pk_bf16_f32 v14, v10, v11
    v_cvt_pk_bf16_f32 v15, v12, v13
    ds_write_b64 v5, v[14:15] offset:0
    s_and_b32 s4, s54, 1
    s_cselect_b64 s[6:7], -1, 0
    v_swap_b32 v52, v124
    v_swap_b32 v53, v125
    v_swap_b32 v54, v126
    v_swap_b32 v55, v127
    v_cndmask_b32 v112, v112, v116, s[6:7]
    v_cndmask_b32 v113, v113, v117, s[6:7]
    v_cndmask_b32 v114, v114, v118, s[6:7]
    v_cndmask_b32 v115, v115, v119, s[6:7]
    v_cndmask_b32 v116, v116, v120, s[6:7]
    v_cndmask_b32 v117, v117, v121, s[6:7]
    v_cndmask_b32 v118, v118, v122, s[6:7]
    v_cndmask_b32 v119, v119, v123, s[6:7]
    s_mul_i32 s4, s4, 14
    s_add_u32 s54, s54, s4
    s_add_u32 s54, s54, 1
    s_lshl_b32 s53, s54, 9
    s_and_b32 s44, s54, 15
    s_lshl_b32 s44, s44, 4
    s_or_b32 s53, s53, s44
    s_cmp_eq_u32 s50, 0
    s_cbranch_scc1 M_GDONE
T_F4:
    v_mfma_f32_16x16x32_bf16 v[10:13], v[52:55], v[112:115], 0
    v_mfma_f32_16x16x32_bf16 v[10:13], v[48:51], v[32:35], v[10:13]
    s_branch T_C4
T_FL4:
    s_bitset0_b32 s56, 4
    s_sub_u32 s50, s50, 1
    s_nop 4
    v_xor_b32 v5, s53, v8
    v_cvt_pk_bf16_f32 v14, v10, v11
    v_cvt_pk_bf16_f32 v15, v12, v13
    ds_write_b64 v5, v[14:15] offset:0
    s_and_b32 s4, s54, 1
    s_cselect_b64 s[6:7], -1, 0
    v_swap_b32 v52, v124
    v_swap_b32 v53, v125
    v_swap_b32 v54, v126
    v_swap_b32 v55, v127
    v_cndmask_b32 v112, v112, v116, s[6:7]
    v_cndmask_b32 v113, v113, v117, s[6:7]
    v_cndmask_b32 v114, v114, v118, s[6:7]
    v_cndmask_b32 v115, v115, v119, s[6:7]
    v_cndmask_b32 v116, v116, v120, s[6:7]
    v_cndmask_b32 v117, v117, v121, s[6:7]
    v_cndmask_b32 v118, v118, v122, s[6:7]
    v_cndmask_b32 v119, v119, v123, s[6:7]
    s_mul_i32 s4, s4, 14
    s_add_u32 s54, s54, s4
    s_add_u32 s54, s54, 1
    s_lshl_b32 s53, s54, 9
    s_and_b32 s44, s54, 15
    s_lshl_b32 s44, s44, 4
    s_or_b32 s53, s53, s44
    s_cmp_eq_u32 s50, 0
    s_cbranch_scc1 M_GDONE
T_F5:
    v_mfma_f32_16x16x32_bf16 v[10:13], v[52:55], v[112:115], 0
    v_mfma_f32_16x16x32_bf16 v[10:13], v[48:51], v[36:39], v[10:13]
    s_branch T_C5
T_FL5:
    s_bitset0_b32 s56, 5
    s_sub_u32 s50, s50, 1
    s_nop 4
    v_xor_b32 v5, s53, v8
    v_cvt_pk_bf16_f32 v14, v10, v11
    v_cvt_pk_bf16_f32 v15, v12, v13
    ds_write_b64 v5, v[14:15] offset:0
    s_and_b32 s4, s54, 1
    s_cselect_b64 s[6:7], -1, 0
    v_swap_b32 v52, v124
    v_swap_b32 v53, v125
    v_swap_b32 v54, v126
    v_swap_b32 v55, v127
    v_cndmask_b32 v112, v112, v116, s[6:7]
    v_cndmask_b32 v113, v113, v117, s[6:7]
    v_cndmask_b32 v114, v114, v118, s[6:7]
    v_cndmask_b32 v115, v115, v119, s[6:7]
    v_cndmask_b32 v116, v116, v120, s[6:7]
    v_cndmask_b32 v117, v117, v121, s[6:7]
    v_cndmask_b32 v118, v118, v122, s[6:7]
    v_cndmask_b32 v119, v119, v123, s[6:7]
    s_mul_i32 s4, s4, 14
    s_add_u32 s54, s54, s4
    s_add_u32 s54, s54, 1
    s_lshl_b32 s53, s54, 9
    s_and_b32 s44, s54, 15
    s_lshl_b32 s44, s44, 4
    s_or_b32 s53, s53, s44
    s_cmp_eq_u32 s50, 0
    s_cbranch_scc1 M_GDONE
T_F6:
    v_mfma_f32_16x16x32_bf16 v[10:13], v[52:55], v[112:115], 0
    v_mfma_f32_16x16x32_bf16 v[10:13], v[48:51], v[40:43], v[10:13]
    s_branch T_C6
T_FL6:
    s_bitset0_b32 s56, 6
    s_sub_u32 s50, s50, 1
    s_nop 4
    v_xor_b32 v5, s53, v8
    v_cvt_pk_bf16_f32 v14, v10, v11
    v_cvt_pk_bf16_f32 v15, v12, v13
    ds_write_b64 v5, v[14:15] offset:0
    s_and_b32 s4, s54, 1
    s_cselect_b64 s[6:7], -1, 0
    v_swap_b32 v52, v124
    v_swap_b32 v53, v125
    v_swap_b32 v54, v126
    v_swap_b32 v55, v127
    v_cndmask_b32 v112, v112, v116, s[6:7]
    v_cndmask_b32 v113, v113, v117, s[6:7]
    v_cndmask_b32 v114, v114, v118, s[6:7]
    v_cndmask_b32 v115, v115, v119, s[6:7]
    v_cndmask_b32 v116, v116, v120, s[6:7]
    v_cndmask_b32 v117, v117, v121, s[6:7]
    v_cndmask_b32 v118, v118, v122, s[6:7]
    v_cndmask_b32 v119, v119, v123, s[6:7]
    s_mul_i32 s4, s4, 14
    s_add_u32 s54, s54, s4
    s_add_u32 s54, s54, 1
    s_lshl_b32 s53, s54, 9
    s_and_b32 s44, s54, 15
    s_lshl_b32 s44, s44, 4
    s_or_b32 s53, s53, s44
    s_cmp_eq_u32 s50, 0
    s_cbranch_scc1 M_GDONE
T_F7:
    v_mfma_f32_16x16x32_bf16 v[10:13], v[52:55], v[112:115], 0
    v_mfma_f32_16x16x32_bf16 v[10:13], v[48:51], v[44:47], v[10:13]
    s_branch T_C7
T_FL7:
    s_bitset0_b32 s56, 7
    s_sub_u32 s50, s50, 1
    s_nop 4
    v_xor_b32 v5, s53, v8
    v_cvt_pk_bf16_f32 v14, v10, v11
    v_cvt_pk_bf16_f32 v15, v12, v13
    ds_write_b64 v5, v[14:15] offset:0
    s_and_b32 s4, s54, 1
    s_cselect_b64 s[6:7], -1, 0
    v_swap_b32 v52, v124
    v_swap_b32 v53, v125
    v_swap_b32 v54, v126
    v_swap_b32 v55, v127
    v_cndmask_b32 v112, v112, v116, s[6:7]
    v_cndmask_b32 v113, v113, v117, s[6:7]
    v_cndmask_b32 v114, v114, v118, s[6:7]
    v_cndmask_b32 v115, v115, v119, s[6:7]
    v_cndmask_b32 v116, v116, v120, s[6:7]
    v_cndmask_b32 v117, v117, v121, s[6:7]
    v_cndmask_b32 v118, v118, v122, s[6:7]
    v_cndmask_b32 v119, v119, v123, s[6:7]
    s_mul_i32 s4, s4, 14
    s_add_u32 s54, s54, s4
    s_add_u32 s54, s54, 1
    s_lshl_b32 s53, s54, 9
    s_and_b32 s44, s54, 15
    s_lshl_b32 s44, s44, 4
    s_or_b32 s53, s53, s44
    s_cmp_eq_u32 s50, 0
    s_cbranch_scc1 M_GDONE
T_F0:
    v_mfma_f32_16x16x32_bf16 v[10:13], v[52:55], v[112:115], 0
    v_mfma_f32_16x16x32_bf16 v[10:13], v[48:51], v[16:19], v[10:13]
    s_branch T_C0
POLL_RETRY:
    s_add_u32 s50, s50, 1
    s_cmp_lt_u32 s50, 30000
    s_cbranch_scc0 POLL_GIVEUP
    s_cmp_eq_u32 s50, 1
    s_cbranch_scc1 POLL_NOSLEEP
POLL_SLEEP:
    s_sleep 4
POLL_NOSLEEP:
    s_cmp_eq_u64 s[78:79], 0
    s_cbranch_scc1 POLL_CELLS
    buffer_load_dword v40, v42, s[72:75], 0 offen sc1
POLL_CELLS:
    buffer_load_dwordx4 v[32:35], v41, s[12:15], s46 offen sc1
    s_waitcnt vmcnt(0)
    s_branch POLL_CHK
POLL_GIVEUP:
    s_cmp_lt_u32 s50, 240000
    s_cbranch_scc0 POLL_GO
    v_cmp_eq_u32 vcc, 0, v39
    s_cmp_lg_u64 vcc, 0
    s_cbranch_scc1 POLL_SLEEP
POLL_GO:
    v_mov_b32 v20, 1015808
    s_mov_b64 s[4:5], -1
    s_branch POLL_OK
FLG_RETRY:
    s_add_u32 s50, s50, 1
    s_cmp_lt_u32 s50, 240000
    s_cbranch_scc0 FLG_OK
    s_sleep 8
    buffer_load_dword v63, v64, s[72:75], 0 offen offset:128 sc1
    s_waitcnt vmcnt(0)
    s_branch FLG_CHK
M_SLOW:
    s_waitcnt vmcnt(0) lgkmcnt(0)
    v_mov_b32 v5, 0x7f000000
    v_cmp_gt_u32 vcc, 32, v1
    s_nop 1
    v_cndmask_b32 v4, v5, v2, vcc
    s_add_u32 s40, s3, s54
    s_add_u32 s4, s40, 0
    s_lshl_b32 s4, s4, 9
    v_add_u32 v7, s4, v4
    buffer_load_dwordx4 v[16:19], v7, s[8:11], 0 offen
    s_waitcnt vmcnt(0)
    v_mfma_f32_16x16x32_bf16 v[24:27], v[52:55], v[16:19], 0
    s_nop 7
    s_add_u32 s4, s40, 1
    s_lshl_b32 s4, s4, 9
    v_add_u32 v7, s4, v4
    buffer_load_dwordx4 v[16:19], v7, s[8:11], 0 offen
    s_waitcnt vmcnt(0)
    v_mfma_f32_16x16x32_bf16 v[28:31], v[52:55], v[16:19], 0
    s_nop 7
    s_add_u32 s4, s40, 16
    s_lshl_b32 s4, s4, 9
    v_add_u32 v7, s4, v4
    buffer_load_dwordx4 v[16:19], v7, s[8:11], 0 offen
    s_waitcnt vmcnt(0)
    v_mfma_f32_16x16x32_bf16 v[32:35], v[52:55], v[16:19], 0
    s_nop 7
    s_add_u32 s4, s40, 17
    s_lshl_b32 s4, s4, 9
    v_add_u32 v7, s4, v4
    buffer_load_dwordx4 v[16:19], v7, s[8:11], 0 offen
    s_waitcnt vmcnt(0)
    v_mfma_f32_16x16x32_bf16 v[36:39], v[52:55], v[16:19], 0
    s_nop 7
    s_add_u32 s4, s40, 32
    s_lshl_b32 s4, s4, 9
    v_add_u32 v7, s4, v4
    buffer_load_dwordx4 v[16:19], v7, s[8:11], 0 offen
    s_waitcnt vmcnt(0)
    v_mfma_f32_16x16x32_bf16 v[40:43], v[52:55], v[16:19], 0
    s_nop 7
    s_add_u32 s4, s40, 33
    s_lshl_b32 s4, s4, 9
    v_add_u32 v7, s4, v4
    buffer_load_dwordx4 v[16:19], v7, s[8:11], 0 offen
    s_waitcnt vmcnt(0)
    v_mfma_f32_16x16x32_bf16 v[44:47], v[52:55], v[16:19], 0
    s_nop 7
    v_lshlrev_b32 v5, 2, v1
    s_mov_b32 s41, 0
S_LOOP:
    buffer_load_dword v20, v5, s[24:27], s41 offen
    buffer_load_dword v21, v5, s[20:23], s41 offen
    s_waitcnt vmcnt(0)
    v_subrev_u32 v20, s40, v20
    v_and_b32 v22, 0xffffffce, v20
    v_cmp_eq_u32 vcc, 0, v22
    v_cmp_gt_u32 s[42:43], 48, v20
    s_nop 3
    s_and_b64 s[42:43], s[42:43], vcc
S_IN:
    s_cmp_eq_u64 s[42:43], 0
    s_cbranch_scc1 S_NEXT
    s_ff1_i32_b64 s44, s[42:43]
    s_bitset0_b64 s[42:43], s44
    v_readlane_b32 s45, v20, s44
    v_readlane_b32 s46, v21, s44
    s_nop 3
    s_lshl_b32 s46, s46, 9
    v_add_u32 v7, s46, v4
    buffer_load_dwordx4 v[16:19], v7, s[8:11], 0 offen
    s_waitcnt vmcnt(0)
    s_cmp_eq_u32 s45, 0
    s_cbranch_scc0 S_J1
    v_mfma_f32_16x16x32_bf16 v[24:27], v[48:51], v[16:19], v[24:27]
    s_nop 7
    s_branch S_IN
S_J1:
    s_cmp_eq_u32 s45, 1
    s_cbranch_scc0 S_J2
    v_mfma_f32_16x16x32_bf16 v[28:31], v[48:51], v[16:19], v[28:31]
    s_nop 7
    s_branch S_IN
S_J2:
    s_cmp_eq_u32 s45, 16
    s_cbranch_scc0 S_J3
    v_mfma_f32_16x16x32_bf16 v[32:35], v[48:51], v[16:19], v[32:35]
    s_nop 7
    s_branch S_IN
S_J3:
    s_cmp_eq_u32 s45, 17
    s_cbranch_scc0 S_J4
    v_mfma_f32_16x16x32_bf16 v[36:39], v[48:51], v[16:19], v[36:39]
    s_nop 7
    s_branch S_IN
S_J4:
    s_cmp_eq_u32 s45, 32
    s_cbranch_scc0 S_J5
    v_mfma_f32_16x16x32_bf16 v[40:43], v[48:51], v[16:19], v[40:43]
    s_nop 7
    s_branch S_IN
S_J5:
    v_mfma_f32_16x16x32_bf16 v[44:47], v[48:51], v[16:19], v[44:47]
    s_nop 7
    s_branch S_IN
S_NEXT:
    s_add_u32 s41, s41, 256
    s_cmp_lt_u32 s41, 640000
    s_cbranch_scc1 S_LOOP
    v_mov_b32 v10, v24
    v_mov_b32 v11, v25
    v_mov_b32 v12, v26
    v_mov_b32 v13, v27
    v_xor_b32 v5, s53, v8
    v_cvt_pk_bf16_f32 v14, v10, v11
    v_cvt_pk_bf16_f32 v15, v12, v13
    ds_write_b64 v5, v[14:15] offset:0
    s_and_b32 s4, s54, 1
    s_cselect_b64 s[6:7], -1, 0
    v_swap_b32 v52, v124
    v_swap_b32 v53, v125
    v_swap_b32 v54, v126
    v_swap_b32 v55, v127
    v_cndmask_b32 v112, v112, v116, s[6:7]
    v_cndmask_b32 v113, v113, v117, s[6:7]
    v_cndmask_b32 v114, v114, v118, s[6:7]
    v_cndmask_b32 v115, v115, v119, s[6:7]
    v_cndmask_b32 v116, v116, v120, s[6:7]
    v_cndmask_b32 v117, v117, v121, s[6:7]
    v_cndmask_b32 v118, v118, v122, s[6:7]
    v_cndmask_b32 v119, v119, v123, s[6:7]
    s_mul_i32 s4, s4, 14
    s_add_u32 s54, s54, s4
    s_add_u32 s54, s54, 1
    s_lshl_b32 s53, s54, 9
    s_and_b32 s44, s54, 15
    s_lshl_b32 s44, s44, 4
    s_or_b32 s53, s53, s44
    v_mov_b32 v10, v28
    v_mov_b32 v11, v29
    v_mov_b32 v12, v30
    v_mov_b32 v13, v31
    v_xor_b32 v5, s53, v8
    v_cvt_pk_bf16_f32 v14, v10, v11
    v_cvt_pk_bf16_f32 v15, v12, v13
    ds_write_b64 v5, v[14:15] offset:0
    s_and_b32 s4, s54, 1
    s_cselect_b64 s[6:7], -1, 0
    v_swap_b32 v52, v124
    v_swap_b32 v53, v125
    v_swap_b32 v54, v126
    v_swap_b32 v55, v127
    v_cndmask_b32 v112, v112, v116, s[6:7]
    v_cndmask_b32 v113, v113, v117, s[6:7]
    v_cndmask_b32 v114, v114, v118, s[6:7]
    v_cndmask_b32 v115, v115, v119, s[6:7]
    v_cndmask_b32 v116, v116, v120, s[6:7]
    v_cndmask_b32 v117, v117, v121, s[6:7]
    v_cndmask_b32 v118, v118, v122, s[6:7]
    v_cndmask_b32 v119, v119, v123, s[6:7]
    s_mul_i32 s4, s4, 14
    s_add_u32 s54, s54, s4
    s_add_u32 s54, s54, 1
    s_lshl_b32 s53, s54, 9
    s_and_b32 s44, s54, 15
    s_lshl_b32 s44, s44, 4
    s_or_b32 s53, s53, s44
    v_mov_b32 v10, v32
    v_mov_b32 v11, v33
    v_mov_b32 v12, v34
    v_mov_b32 v13, v35
    v_xor_b32 v5, s53, v8
    v_cvt_pk_bf16_f32 v14, v10, v11
    v_cvt_pk_bf16_f32 v15, v12, v13
    ds_write_b64 v5, v[14:15] offset:0
    s_and_b32 s4, s54, 1
    s_cselect_b64 s[6:7], -1, 0
    v_swap_b32 v52, v124
    v_swap_b32 v53, v125
    v_swap_b32 v54, v126
    v_swap_b32 v55, v127
    v_cndmask_b32 v112, v112, v116, s[6:7]
    v_cndmask_b32 v113, v113, v117, s[6:7]
    v_cndmask_b32 v114, v114, v118, s[6:7]
    v_cndmask_b32 v115, v115, v119, s[6:7]
    v_cndmask_b32 v116, v116, v120, s[6:7]
    v_cndmask_b32 v117, v117, v121, s[6:7]
    v_cndmask_b32 v118, v118, v122, s[6:7]
    v_cndmask_b32 v119, v119, v123, s[6:7]
    s_mul_i32 s4, s4, 14
    s_add_u32 s54, s54, s4
    s_add_u32 s54, s54, 1
    s_lshl_b32 s53, s54, 9
    s_and_b32 s44, s54, 15
    s_lshl_b32 s44, s44, 4
    s_or_b32 s53, s53, s44
    v_mov_b32 v10, v36
    v_mov_b32 v11, v37
    v_mov_b32 v12, v38
    v_mov_b32 v13, v39
    v_xor_b32 v5, s53, v8
    v_cvt_pk_bf16_f32 v14, v10, v11
    v_cvt_pk_bf16_f32 v15, v12, v13
    ds_write_b64 v5, v[14:15] offset:0
    s_and_b32 s4, s54, 1
    s_cselect_b64 s[6:7], -1, 0
    v_swap_b32 v52, v124
    v_swap_b32 v53, v125
    v_swap_b32 v54, v126
    v_swap_b32 v55, v127
    v_cndmask_b32 v112, v112, v116, s[6:7]
    v_cndmask_b32 v113, v113, v117, s[6:7]
    v_cndmask_b32 v114, v114, v118, s[6:7]
    v_cndmask_b32 v115, v115, v119, s[6:7]
    v_cndmask_b32 v116, v116, v120, s[6:7]
    v_cndmask_b32 v117, v117, v121, s[6:7]
    v_cndmask_b32 v118, v118, v122, s[6:7]
    v_cndmask_b32 v119, v119, v123, s[6:7]
    s_mul_i32 s4, s4, 14
    s_add_u32 s54, s54, s4
    s_add_u32 s54, s54, 1
    s_lshl_b32 s53, s54, 9
    s_and_b32 s44, s54, 15
    s_lshl_b32 s44, s44, 4
    s_or_b32 s53, s53, s44
    v_mov_b32 v10, v40
    v_mov_b32 v11, v41
    v_mov_b32 v12, v42
    v_mov_b32 v13, v43
    v_xor_b32 v5, s53, v8
    v_cvt_pk_bf16_f32 v14, v10, v11
    v_cvt_pk_bf16_f32 v15, v12, v13
    ds_write_b64 v5, v[14:15] offset:0
    s_and_b32 s4, s54, 1
    s_cselect_b64 s[6:7], -1, 0
    v_swap_b32 v52, v124
    v_swap_b32 v53, v125
    v_swap_b32 v54, v126
    v_swap_b32 v55, v127
    v_cndmask_b32 v112, v112, v116, s[6:7]
    v_cndmask_b32 v113, v113, v117, s[6:7]
    v_cndmask_b32 v114, v114, v118, s[6:7]
    v_cndmask_b32 v115, v115, v119, s[6:7]
    v_cndmask_b32 v116, v116, v120, s[6:7]
    v_cndmask_b32 v117, v117, v121, s[6:7]
    v_cndmask_b32 v118, v118, v122, s[6:7]
    v_cndmask_b32 v119, v119, v123, s[6:7]
    s_mul_i32 s4, s4, 14
    s_add_u32 s54, s54, s4
    s_add_u32 s54, s54, 1
    s_lshl_b32 s53, s54, 9
    s_and_b32 s44, s54, 15
    s_lshl_b32 s44, s44, 4
    s_or_b32 s53, s53, s44
    v_mov_b32 v10, v44
    v_mov_b32 v11, v45
    v_mov_b32 v12, v46
    v_mov_b32 v13, v47
    v_xor_b32 v5, s53, v8
    v_cvt_pk_bf16_f32 v14, v10, v11
    v_cvt_pk_bf16_f32 v15, v12, v13
    ds_write_b64 v5, v[14:15] offset:0
    s_and_b32 s4, s54, 1
    s_cselect_b64 s[6:7], -1, 0
    v_swap_b32 v52, v124
    v_swap_b32 v53, v125
    v_swap_b32 v54, v126
    v_swap_b32 v55, v127
    v_cndmask_b32 v112, v112, v116, s[6:7]
    v_cndmask_b32 v113, v113, v117, s[6:7]
    v_cndmask_b32 v114, v114, v118, s[6:7]
    v_cndmask_b32 v115, v115, v119, s[6:7]
    v_cndmask_b32 v116, v116, v120, s[6:7]
    v_cndmask_b32 v117, v117, v121, s[6:7]
    v_cndmask_b32 v118, v118, v122, s[6:7]
    v_cndmask_b32 v119, v119, v123, s[6:7]
    s_mul_i32 s4, s4, 14
    s_add_u32 s54, s54, s4
    s_add_u32 s54, s54, 1
    s_lshl_b32 s53, s54, 9
    s_and_b32 s44, s54, 15
    s_lshl_b32 s44, s44, 4
    s_or_b32 s53, s53, s44
M_GDONE:
    s_mov_b32 s50, 0
FLG_CHK:
    v_cmp_eq_u32 vcc, 0, v63
    s_cmp_lg_u64 vcc, 0
    s_cbranch_scc1 FLG_RETRY
FLG_OK:
    v_and_b32 v48, 15, v1
    v_lshrrev_b32 v49, 4, v1
    s_lshl_b32 s4, s49, 8
    s_add_u32 s4, s4, 139264
    v_lshl_add_u32 v1, v49, 4, s4
    ds_read_b128 v[16:19], v1 offset:0
    ds_read_b128 v[20:23], v1 offset:64
    ds_read_b128 v[24:27], v1 offset:128
    ds_read_b128 v[28:31], v1 offset:192
    ds_read_b128 v[32:35], v1 offset:0
    ds_read_b128 v[36:39], v1 offset:64
    ds_read_b128 v[40:43], v1 offset:128
    ds_read_b128 v[44:47], v1 offset:192
    s_lshl_b32 s4, s47, 2
    v_xor_b32 v62, v49, v48
    v_xor_b32 v2, s4, v62
    v_lshlrev_b32 v2, 4, v2
    v_lshl_or_b32 v2, v48, 9, v2
    v_xor_b32 v3, 64, v2
    v_xor_b32 v4, 128, v2
    v_xor_b32 v7, 192, v2
    v_xor_b32 v8, 256, v2
    v_xor_b32 v9, 320, v2
    v_xor_b32 v14, 384, v2
    v_xor_b32 v15, 448, v2
    v_lshlrev_b32 v62, 4, v62
    v_lshl_or_b32 v62, v48, 10, v62
    s_lshl_b32 s4, s49, 3
    v_or_b32 v57, s4, v49
    v_xor_b32 v57, v57, v48
    v_lshlrev_b32 v57, 4, v57
    v_lshl_or_b32 v57, v48, 10, v57
    s_lshl_b32 s4, s49, 7
    s_add_u32 s4, s4, 141312
    v_lshl_add_u32 v6, v49, 5, s4
    s_lshl_b32 s6, s3, 9
    s_lshl_b32 s7, s49, 6
    s_add_u32 s6, s6, s7
    v_lshlrev_b32 v5, 4, v49
    v_lshl_or_b32 v5, v48, 9, v5
    v_add_u32 v5, s6, v5
    v_xor_b32 v0, 64, v62
    v_xor_b32 v63, 128, v62
    s_waitcnt lgkmcnt(0)
    s_barrier
    ds_read_b128 v[48:51], v2 offset:0
    ds_read_b128 v[52:55], v3 offset:0
    ds_read_b128 v[58:61], v4 offset:0
    s_setprio 3
    s_waitcnt lgkmcnt(2)
    v_mfma_f32_16x16x32_bf16 v[16:19], v[128:131], v[48:51], v[16:19]
    ds_read_b128 v[10:13], v7 offset:0
    v_mfma_f32_16x16x32_bf16 v[20:23], v[132:135], v[48:51], v[20:23]
    s_mov_b32 s38, 0
    buffer_load_dwordx4 v[64:67], v56, s[12:15], s38 offen offset:0 sc1
    v_mfma_f32_16x16x32_bf16 v[24:27], v[136:139], v[48:51], v[24:27]
    v_mfma_f32_16x16x32_bf16 v[28:31], v[140:143], v[48:51], v[28:31]
    s_waitcnt lgkmcnt(2)
    v_mfma_f32_16x16x32_bf16 v[16:19], v[144:147], v[52:55], v[16:19]
    ds_read_b128 v[48:51], v8 offset:0
    v_mfma_f32_16x16x32_bf16 v[20:23], v[148:151], v[52:55], v[20:23]
    buffer_load_dwordx4 v[68:71], v56, s[12:15], s38 offen offset:1024 sc1
    v_mfma_f32_16x16x32_bf16 v[24:27], v[152:155], v[52:55], v[24:27]
    v_mfma_f32_16x16x32_bf16 v[28:31], v[156:159], v[52:55], v[28:31]
    s_waitcnt lgkmcnt(2)
    v_mfma_f32_16x16x32_bf16 v[16:19], v[160:163], v[58:61], v[16:19]
    ds_read_b128 v[52:55], v9 offset:0
    v_mfma_f32_16x16x32_bf16 v[20:23], v[164:167], v[58:61], v[20:23]
    buffer_load_dwordx4 v[72:75], v56, s[12:15], s38 offen offset:2048 sc1
    v_mfma_f32_16x16x32_bf16 v[24:27], v[168:171], v[58:61], v[24:27]
    v_mfma_f32_16x16x32_bf16 v[28:31], v[172:175], v[58:61], v[28:31]
    s_waitcnt lgkmcnt(2)
    v_mfma_f32_16x16x32_bf16 v[16:19], v[176:179], v[10:13], v[16:19]
    ds_read_b128 v[58:61], v14 offset:0
    v_mfma_f32_16x16x32_bf16 v[20:23], v[180:183], v[10:13], v[20:23]
    buffer_load_dwordx4 v[76:79], v56, s[12:15], s38 offen offset:3072 sc1
    v_mfma_f32_16x16x32_bf16 v[24:27], v[184:187], v[10:13], v[24:27]
    v_mfma_f32_16x16x32_bf16 v[28:31], v[188:191], v[10:13], v[28:31]
    s_waitcnt lgkmcnt(2)
    v_mfma_f32_16x16x32_bf16 v[16:19], v[192:195], v[48:51], v[16:19]
    ds_read_b128 v[10:13], v15 offset:0
    v_mfma_f32_16x16x32_bf16 v[20:23], v[196:199], v[48:51], v[20:23]
    s_mov_b32 s38, 4096
    buffer_load_dwordx4 v[80:83], v56, s[12:15], s38 offen offset:0 sc1
    v_mfma_f32_16x16x32_bf16 v[24:27], v[200:203], v[48:51], v[24:27]
    v_mfma_f32_16x16x32_bf16 v[28:31], v[204:207], v[48:51], v[28:31]
    s_setprio 2
    s_waitcnt lgkmcnt(2)
    v_mfma_f32_16x16x32_bf16 v[16:19], v[208:211], v[52:55], v[16:19]
    ds_read_b128 v[48:51], v2 offset:8192
    v_mfma_f32_16x16x32_bf16 v[20:23], v[212:215], v[52:55], v[20:23]
    buffer_load_dwordx4 v[84:87], v56, s[12:15], s38 offen offset:1024 sc1
    v_mfma_f32_16x16x32_bf16 v[24:27], v[216:219], v[52:55], v[24:27]
    v_mfma_f32_16x16x32_bf16 v[28:31], v[220:223], v[52:55], v[28:31]
    s_waitcnt lgkmcnt(2)
    v_mfma_f32_16x16x32_bf16 v[16:19], v[224:227], v[58:61], v[16:19]
    ds_read_b128 v[52:55], v3 offset:8192
    v_mfma_f32_16x16x32_bf16 v[20:23], v[228:231], v[58:61], v[20:23]
    buffer_load_dwordx4 v[88:91], v56, s[12:15], s38 offen offset:2048 sc1
    v_mfma_f32_16x16x32_bf16 v[24:27], v[232:235], v[58:61], v[24:27]
    v_mfma_f32_16x16x32_bf16 v[28:31], v[236:239], v[58:61], v[28:31]
    s_waitcnt lgkmcnt(2)
    v_mfma_f32_16x16x32_bf16 v[16:19], v[240:243], v[10:13], v[16:19]
    ds_read_b128 v[58:61], v4 offset:8192
    v_mfma_f32_16x16x32_bf16 v[20:23], v[244:247], v[10:13], v[20:23]
    buffer_load_dwordx4 v[92:95], v56, s[12:15], s38 offen offset:3072 sc1
    v_mfma_f32_16x16x32_bf16 v[24:27], v[248:251], v[10:13], v[24:27]
    v_mfma_f32_16x16x32_bf16 v[28:31], v[252:255], v[10:13], v[28:31]
    s_waitcnt lgkmcnt(2)
    v_mfma_f32_16x16x32_bf16 v[32:35], v[128:131], v[48:51], v[32:35]
    ds_read_b128 v[10:13], v7 offset:8192
    v_mfma_f32_16x16x32_bf16 v[36:39], v[132:135], v[48:51], v[36:39]
    s_mov_b32 s38, 8192
    buffer_load_dwordx4 v[96:99], v56, s[12:15], s38 offen offset:0 sc1
    v_mfma_f32_16x16x32_bf16 v[40:43], v[136:139], v[48:51], v[40:43]
    v_mfma_f32_16x16x32_bf16 v[44:47], v[140:143], v[48:51], v[44:47]
    s_waitcnt lgkmcnt(2)
    v_mfma_f32_16x16x32_bf16 v[32:35], v[144:147], v[52:55], v[32:35]
    ds_read_b128 v[48:51], v8 offset:8192
    v_mfma_f32_16x16x32_bf16 v[36:39], v[148:151], v[52:55], v[36:39]
    buffer_load_dwordx4 v[100:103], v56, s[12:15], s38 offen offset:1024 sc1
    v_mfma_f32_16x16x32_bf16 v[40:43], v[152:155], v[52:55], v[40:43]
    v_cvt_pk_bf16_f32 v16, v16, v17
    v_cvt_pk_bf16_f32 v17, v18, v19
    v_mfma_f32_16x16x32_bf16 v[44:47], v[156:159], v[52:55], v[44:47]
    v_cvt_pk_bf16_f32 v18, v20, v21
    s_setprio 1
    s_waitcnt lgkmcnt(2)
    v_mfma_f32_16x16x32_bf16 v[32:35], v[160:163], v[58:61], v[32:35]
    ds_read_b128 v[52:55], v9 offset:8192
    v_cvt_pk_bf16_f32 v19, v22, v23
    v_mfma_f32_16x16x32_bf16 v[36:39], v[164:167], v[58:61], v[36:39]
    buffer_load_dwordx4 v[104:107], v56, s[12:15], s38 offen offset:2048 sc1
    v_pk_max_i16 v16, v16, 0
    v_mfma_f32_16x16x32_bf16 v[40:43], v[168:171], v[58:61], v[40:43]
    v_pk_max_i16 v17, v17, 0
    v_pk_max_i16 v18, v18, 0
    v_mfma_f32_16x16x32_bf16 v[44:47], v[172:175], v[58:61], v[44:47]
    v_pk_max_i16 v19, v19, 0
    s_waitcnt lgkmcnt(2)
    v_mfma_f32_16x16x32_bf16 v[32:35], v[176:179], v[10:13], v[32:35]
    ds_read_b128 v[58:61], v14 offset:8192
    ds_write_b128 v57, v[16:19] offset:24576
    v_mfma_f32_16x16x32_bf16 v[36:39], v[180:183], v[10:13], v[36:39]
    buffer_load_dwordx4 v[108:111], v56, s[12:15], s38 offen offset:3072 sc1
    v_cvt_pk_bf16_f32 v24, v24, v25
    v_mfma_f32_16x16x32_bf16 v[40:43], v[184:187], v[10:13], v[40:43]
    v_cvt_pk_bf16_f32 v25, v26, v27
    v_cvt_pk_bf16_f32 v26, v28, v29
    v_mfma_f32_16x16x32_bf16 v[44:47], v[188:191], v[10:13], v[44:47]
    v_cvt_pk_bf16_f32 v27, v30, v31
    s_waitcnt lgkmcnt(3)
    v_mfma_f32_16x16x32_bf16 v[32:35], v[192:195], v[48:51], v[32:35]
    ds_read_b128 v[10:13], v15 offset:8192
    v_pk_max_i16 v24, v24, 0
    v_mfma_f32_16x16x32_bf16 v[36:39], v[196:199], v[48:51], v[36:39]
    s_mov_b32 s38, 12288
    buffer_load_dwordx4 v[112:115], v56, s[12:15], s38 offen offset:0 sc1
    v_pk_max_i16 v25, v25, 0
    v_mfma_f32_16x16x32_bf16 v[40:43], v[200:203], v[48:51], v[40:43]
    v_pk_max_i16 v26, v26, 0
    v_pk_max_i16 v27, v27, 0
    v_mfma_f32_16x16x32_bf16 v[44:47], v[204:207], v[48:51], v[44:47]
    v_xor_b32 v28, 64, v57
    s_waitcnt lgkmcnt(3)
    v_mfma_f32_16x16x32_bf16 v[32:35], v[208:211], v[52:55], v[32:35]
    ds_read_b128 v[48:51], v2 offset:16384
    ds_write_b128 v28, v[24:27] offset:24576
    v_mfma_f32_16x16x32_bf16 v[36:39], v[212:215], v[52:55], v[36:39]
    buffer_load_dwordx4 v[116:119], v56, s[12:15], s38 offen offset:1024 sc1
    s_waitcnt lgkmcnt(0)
    v_mfma_f32_16x16x32_bf16 v[40:43], v[216:219], v[52:55], v[40:43]
    ds_read_b128 v[16:19], v1 offset:0
    ds_read_b128 v[20:23], v1 offset:64
    v_mfma_f32_16x16x32_bf16 v[44:47], v[220:223], v[52:55], v[44:47]
    ds_read_b128 v[24:27], v1 offset:128
    v_mfma_f32_16x16x32_bf16 v[32:35], v[224:227], v[58:61], v[32:35]
    ds_read_b128 v[52:55], v3 offset:16384
    ds_read_b128 v[28:31], v1 offset:192
    v_mfma_f32_16x16x32_bf16 v[36:39], v[228:231], v[58:61], v[36:39]
    buffer_load_dwordx4 v[120:123], v56, s[12:15], s38 offen offset:2048 sc1
    v_mfma_f32_16x16x32_bf16 v[40:43], v[232:235], v[58:61], v[40:43]
    v_mfma_f32_16x16x32_bf16 v[44:47], v[236:239], v[58:61], v[44:47]
    s_setprio 0
    v_mfma_f32_16x16x32_bf16 v[32:35], v[240:243], v[10:13], v[32:35]
    ds_read_b128 v[58:61], v4 offset:16384
    v_mfma_f32_16x16x32_bf16 v[36:39], v[244:247], v[10:13], v[36:39]
    buffer_load_dwordx4 v[124:127], v56, s[12:15], s38 offen offset:3072 sc1
    v_mfma_f32_16x16x32_bf16 v[40:43], v[248:251], v[10:13], v[40:43]
    v_mfma_f32_16x16x32_bf16 v[44:47], v[252:255], v[10:13], v[44:47]
    s_waitcnt lgkmcnt(1)
    v_mfma_f32_16x16x32_bf16 v[16:19], v[128:131], v[48:51], v[16:19]
    ds_read_b128 v[10:13], v7 offset:16384
    v_mfma_f32_16x16x32_bf16 v[20:23], v[132:135], v[48:51], v[20:23]
    v_xor_b32 v2, 192, v62
    v_mfma_f32_16x16x32_bf16 v[24:27], v[136:139], v[48:51], v[24:27]
    v_mfma_f32_16x16x32_bf16 v[28:31], v[140:143], v[48:51], v[28:31]
    s_mov_b32 s38, 16384
    buffer_load_dwordx4 v[128:131], v56, s[12:15], s38 offen offset:0 sc1
    v_mfma_f32_16x16x32_bf16 v[16:19], v[144:147], v[52:55], v[16:19]
    ds_read_b128 v[48:51], v8 offset:16384
    v_cvt_pk_bf16_f32 v32, v32, v33
    v_mfma_f32_16x16x32_bf16 v[20:23], v[148:151], v[52:55], v[20:23]
    v_cvt_pk_bf16_f32 v33, v34, v35
    v_cvt_pk_bf16_f32 v34, v36, v37
    v_mfma_f32_16x16x32_bf16 v[24:27], v[152:155], v[52:55], v[24:27]
    v_cvt_pk_bf16_f32 v35, v38, v39
    v_pk_max_i16 v32, v32, 0
    v_mfma_f32_16x16x32_bf16 v[28:31], v[156:159], v[52:55], v[28:31]
    buffer_load_dwordx4 v[132:135], v56, s[12:15], s38 offen offset:1024 sc1
    s_waitcnt lgkmcnt(2)
    v_mfma_f32_16x16x32_bf16 v[16:19], v[160:163], v[58:61], v[16:19]
    ds_read_b128 v[52:55], v9 offset:16384
    v_pk_max_i16 v33, v33, 0
    v_mfma_f32_16x16x32_bf16 v[20:23], v[164:167], v[58:61], v[20:23]
    v_pk_max_i16 v34, v34, 0
    v_pk_max_i16 v35, v35, 0
    v_mfma_f32_16x16x32_bf16 v[24:27], v[168:171], v[58:61], v[24:27]
    ds_write_b128 v57, v[32:35] offset:40960
    v_cvt_pk_bf16_f32 v40, v40, v41
    v_mfma_f32_16x16x32_bf16 v[28:31], v[172:175], v[58:61], v[28:31]
    buffer_load_dwordx4 v[136:139], v56, s[12:15], s38 offen offset:2048 sc1
    s_waitcnt lgkmcnt(3)
    v_mfma_f32_16x16x32_bf16 v[16:19], v[176:179], v[10:13], v[16:19]
    ds_read_b128 v[58:61], v14 offset:16384
    v_cvt_pk_bf16_f32 v41, v42, v43
    v_mfma_f32_16x16x32_bf16 v[20:23], v[180:183], v[10:13], v[20:23]
    v_cvt_pk_bf16_f32 v42, v44, v45
    v_cvt_pk_bf16_f32 v43, v46, v47
    v_mfma_f32_16x16x32_bf16 v[24:27], v[184:187], v[10:13], v[24:27]
    v_pk_max_i16 v40, v40, 0
    v_pk_max_i16 v41, v41, 0
    v_mfma_f32_16x16x32_bf16 v[28:31], v[188:191], v[10:13], v[28:31]
    buffer_load_dwordx4 v[140:143], v56, s[12:15], s38 offen offset:3072 sc1
    s_waitcnt lgkmcnt(3)
    v_mfma_f32_16x16x32_bf16 v[16:19], v[192:195], v[48:51], v[16:19]
    ds_read_b128 v[10:13], v15 offset:16384
    v_pk_max_i16 v42, v42, 0
    v_mfma_f32_16x16x32_bf16 v[20:23], v[196:199], v[48:51], v[20:23]
    v_pk_max_i16 v43, v43, 0
    v_xor_b32 v44, 64, v57
    ds_write_b128 v44, v[40:43] offset:40960
    v_mfma_f32_16x16x32_bf16 v[24:27], v[200:203], v[48:51], v[24:27]
    v_mfma_f32_16x16x32_bf16 v[28:31], v[204:207], v[48:51], v[28:31]
    s_mov_b32 s38, 20480
    buffer_load_dwordx4 v[144:147], v56, s[12:15], s38 offen offset:0 sc1
    s_waitcnt lgkmcnt(0)
    s_barrier
    s_setprio 3
    v_mfma_f32_16x16x32_bf16 v[16:19], v[208:211], v[52:55], v[16:19]
    ds_read_b128 v[48:51], v62 offset:24576
    v_mfma_f32_16x16x32_bf16 v[20:23], v[212:215], v[52:55], v[20:23]
    ds_read_b128 v[192:195], v6 offset:0
    ds_read_b128 v[196:199], v6 offset:16
    v_mfma_f32_16x16x32_bf16 v[24:27], v[216:219], v[52:55], v[24:27]
    ds_read_b128 v[32:35], v0 offset:24576
    ds_read_b128 v[200:203], v6 offset:0
    v_mfma_f32_16x16x32_bf16 v[28:31], v[220:223], v[52:55], v[28:31]
    buffer_load_dwordx4 v[148:151], v56, s[12:15], s38 offen offset:1024 sc1
    v_mfma_f32_16x16x32_bf16 v[16:19], v[224:227], v[58:61], v[16:19]
    ds_read_b128 v[52:55], v63 offset:24576
    ds_read_b128 v[204:207], v6 offset:16
    v_mfma_f32_16x16x32_bf16 v[20:23], v[228:231], v[58:61], v[20:23]
    ds_read_b128 v[208:211], v6 offset:0
    ds_read_b128 v[212:215], v6 offset:16
    v_mfma_f32_16x16x32_bf16 v[24:27], v[232:235], v[58:61], v[24:27]
    ds_read_b128 v[36:39], v2 offset:24576
    v_mfma_f32_16x16x32_bf16 v[28:31], v[236:239], v[58:61], v[28:31]
    buffer_load_dwordx4 v[152:155], v56, s[12:15], s38 offen offset:2048 sc1
    s_setprio 2
    v_mfma_f32_16x16x32_bf16 v[16:19], v[240:243], v[10:13], v[16:19]
    ds_read_b128 v[58:61], v62 offset:24832
    v_mfma_f32_16x16x32_bf16 v[20:23], v[244:247], v[10:13], v[20:23]
    v_mfma_f32_16x16x32_bf16 v[24:27], v[248:251], v[10:13], v[24:27]
    ds_read_b128 v[40:43], v0 offset:24832
    v_mfma_f32_16x16x32_bf16 v[28:31], v[252:255], v[10:13], v[28:31]
    buffer_load_dwordx4 v[156:159], v56, s[12:15], s38 offen offset:3072 sc1
    s_waitcnt vmcnt(20) lgkmcnt(8)
    v_mfma_f32_16x16x32_bf16 v[192:195], v[64:67], v[48:51], v[192:195]
    ds_read_b128 v[10:13], v63 offset:24832
    v_mfma_f32_16x16x32_bf16 v[196:199], v[68:71], v[48:51], v[196:199]
    v_mfma_f32_16x16x32_bf16 v[192:195], v[72:75], v[32:35], v[192:195]
    ds_read_b128 v[44:47], v2 offset:24832
    v_mfma_f32_16x16x32_bf16 v[196:199], v[76:79], v[32:35], v[196:199]
    s_mov_b32 s38, 24576
    buffer_load_dwordx4 v[160:163], v56, s[12:15], s38 offen offset:0 sc1
    s_setprio 1
    s_waitcnt vmcnt(17) lgkmcnt(4)
    v_mfma_f32_16x16x32_bf16 v[192:195], v[80:83], v[52:55], v[192:195]
    ds_read_b128 v[48:51], v62 offset:40960
    v_cvt_pk_bf16_f32 v16, v16, v17
    v_mfma_f32_16x16x32_bf16 v[196:199], v[84:87], v[52:55], v[196:199]
    v_cvt_pk_bf16_f32 v17, v18, v19
    v_cvt_pk_bf16_f32 v18, v20, v21
    v_mfma_f32_16x16x32_bf16 v[192:195], v[88:91], v[36:39], v[192:195]
    ds_read_b128 v[32:35], v0 offset:40960
    v_cvt_pk_bf16_f32 v19, v22, v23
    v_mfma_f32_16x16x32_bf16 v[196:199], v[92:95], v[36:39], v[196:199]
    buffer_load_dwordx4 v[164:167], v56, s[12:15], s38 offen offset:1024 sc1
    s_waitcnt vmcnt(14) lgkmcnt(4)
    v_mfma_f32_16x16x32_bf16 v[192:195], v[96:99], v[58:61], v[192:195]
    ds_read_b128 v[52:55], v63 offset:40960
    v_pk_max_i16 v16, v16, 0
    v_mfma_f32_16x16x32_bf16 v[196:199], v[100:103], v[58:61], v[196:199]
    v_pk_max_i16 v17, v17, 0
    v_pk_max_i16 v18, v18, 0
    v_mfma_f32_16x16x32_bf16 v[192:195], v[104:107], v[40:43], v[192:195]
    ds_read_b128 v[36:39], v2 offset:40960
    v_pk_max_i16 v19, v19, 0
    v_mfma_f32_16x16x32_bf16 v[196:199], v[108:111], v[40:43], v[196:199]
    buffer_load_dwordx4 v[168:171], v56, s[12:15], s38 offen offset:2048 sc1
    s_setprio 0
    s_waitcnt vmcnt(11) lgkmcnt(4)
    v_mfma_f32_16x16x32_bf16 v[192:195], v[112:115], v[10:13], v[192:195]
    ds_read_b128 v[58:61], v62 offset:41216
    ds_write_b128 v57, v[16:19] offset:57344
    v_mfma_f32_16x16x32_bf16 v[196:199], v[116:119], v[10:13], v[196:199]
    v_cvt_pk_bf16_f32 v24, v24, v25
    v_cvt_pk_bf16_f32 v25, v26, v27
    v_mfma_f32_16x16x32_bf16 v[192:195], v[120:123], v[44:47], v[192:195]
    ds_read_b128 v[40:43], v0 offset:41216
    v_cvt_pk_bf16_f32 v26, v28, v29
    v_mfma_f32_16x16x32_bf16 v[196:199], v[124:127], v[44:47], v[196:199]
    buffer_load_dwordx4 v[172:175], v56, s[12:15], s38 offen offset:3072 sc1
    s_waitcnt lgkmcnt(5)
    v_mfma_f32_16x16x32_bf16 v[200:203], v[64:67], v[48:51], v[200:203]
    ds_read_b128 v[10:13], v63 offset:41216
    v_cvt_pk_bf16_f32 v27, v30, v31
    v_mfma_f32_16x16x32_bf16 v[204:207], v[68:71], v[48:51], v[204:207]
    v_pk_max_i16 v24, v24, 0
    v_pk_max_i16 v25, v25, 0
    v_pk_max_i16 v26, v26, 0
    v_pk_max_i16 v27, v27, 0
    v_xor_b32 v28, 64, v57
    ds_write_b128 v28, v[24:27] offset:57344
    v_mfma_f32_16x16x32_bf16 v[200:203], v[72:75], v[32:35], v[200:203]
    ds_read_b128 v[44:47], v2 offset:41216
    v_mfma_f32_16x16x32_bf16 v[204:207], v[76:79], v[32:35], v[204:207]
    s_mov_b32 s38, 28672
    buffer_load_dwordx4 v[176:179], v56, s[12:15], s38 offen offset:0 sc1
    s_waitcnt lgkmcnt(1)
    s_barrier
    s_setprio 3
    v_mfma_f32_16x16x32_bf16 v[200:203], v[80:83], v[52:55], v[200:203]
    ds_read_b128 v[48:51], v62 offset:57344
    v_mfma_f32_16x16x32_bf16 v[204:207], v[84:87], v[52:55], v[204:207]
    v_mfma_f32_16x16x32_bf16 v[200:203], v[88:91], v[36:39], v[200:203]
    ds_read_b128 v[32:35], v0 offset:57344
    v_mfma_f32_16x16x32_bf16 v[204:207], v[92:95], v[36:39], v[204:207]
    buffer_load_dwordx4 v[180:183], v56, s[12:15], s38 offen offset:1024 sc1
    v_mfma_f32_16x16x32_bf16 v[200:203], v[96:99], v[58:61], v[200:203]
    ds_read_b128 v[52:55], v63 offset:57344
    v_mfma_f32_16x16x32_bf16 v[204:207], v[100:103], v[58:61], v[204:207]
    v_mfma_f32_16x16x32_bf16 v[200:203], v[104:107], v[40:43], v[200:203]
    ds_read_b128 v[36:39], v2 offset:57344
    v_mfma_f32_16x16x32_bf16 v[204:207], v[108:111], v[40:43], v[204:207]
    buffer_load_dwordx4 v[184:187], v56, s[12:15], s38 offen offset:2048 sc1
    s_waitcnt lgkmcnt(4)
    v_mfma_f32_16x16x32_bf16 v[200:203], v[112:115], v[10:13], v[200:203]
    ds_read_b128 v[58:61], v62 offset:57600
    v_mfma_f32_16x16x32_bf16 v[204:207], v[116:119], v[10:13], v[204:207]
    v_mfma_f32_16x16x32_bf16 v[200:203], v[120:123], v[44:47], v[200:203]
    ds_read_b128 v[40:43], v0 offset:57600
    v_mfma_f32_16x16x32_bf16 v[204:207], v[124:127], v[44:47], v[204:207]
    buffer_load_dwordx4 v[188:191], v56, s[12:15], s38 offen offset:3072 sc1
    s_waitcnt lgkmcnt(4)
    v_mfma_f32_16x16x32_bf16 v[208:211], v[64:67], v[48:51], v[208:211]
    ds_read_b128 v[10:13], v63 offset:57600
    v_mfma_f32_16x16x32_bf16 v[212:215], v[68:71], v[48:51], v[212:215]
    v_mfma_f32_16x16x32_bf16 v[208:211], v[72:75], v[32:35], v[208:211]
    ds_read_b128 v[44:47], v2 offset:57600
    v_mfma_f32_16x16x32_bf16 v[212:215], v[76:79], v[32:35], v[212:215]
    s_setprio 2
    s_waitcnt lgkmcnt(4)
    v_mfma_f32_16x16x32_bf16 v[208:211], v[80:83], v[52:55], v[208:211]
    ds_read_b128 v[48:51], v62 offset:25088
    v_mfma_f32_16x16x32_bf16 v[212:215], v[84:87], v[52:55], v[212:215]
    v_mfma_f32_16x16x32_bf16 v[208:211], v[88:91], v[36:39], v[208:211]
    ds_read_b128 v[32:35], v0 offset:25088
    v_mfma_f32_16x16x32_bf16 v[212:215], v[92:95], v[36:39], v[212:215]
    s_waitcnt lgkmcnt(4)
    v_mfma_f32_16x16x32_bf16 v[208:211], v[96:99], v[58:61], v[208:211]
    ds_read_b128 v[52:55], v63 offset:25088
    v_mfma_f32_16x16x32_bf16 v[212:215], v[100:103], v[58:61], v[212:215]
    v_mfma_f32_16x16x32_bf16 v[208:211], v[104:107], v[40:43], v[208:211]
    ds_read_b128 v[36:39], v2 offset:25088
    v_mfma_f32_16x16x32_bf16 v[212:215], v[108:111], v[40:43], v[212:215]
    s_waitcnt lgkmcnt(4)
    v_mfma_f32_16x16x32_bf16 v[208:211], v[112:115], v[10:13], v[208:211]
    ds_read_b128 v[58:61], v62 offset:25344
    v_mfma_f32_16x16x32_bf16 v[212:215], v[116:119], v[10:13], v[212:215]
    v_mfma_f32_16x16x32_bf16 v[208:211], v[120:123], v[44:47], v[208:211]
    ds_read_b128 v[40:43], v0 offset:25344
    v_mfma_f32_16x16x32_bf16 v[212:215], v[124:127], v[44:47], v[212:215]
    s_waitcnt vmcnt(12) lgkmcnt(4)
    v_mfma_f32_16x16x32_bf16 v[192:195], v[128:131], v[48:51], v[192:195]
    ds_read_b128 v[10:13], v63 offset:25344
    v_mfma_f32_16x16x32_bf16 v[196:199], v[132:135], v[48:51], v[196:199]
    v_mfma_f32_16x16x32_bf16 v[192:195], v[136:139], v[32:35], v[192:195]
    ds_read_b128 v[44:47], v2 offset:25344
    v_mfma_f32_16x16x32_bf16 v[196:199], v[140:143], v[32:35], v[196:199]
    s_waitcnt vmcnt(8) lgkmcnt(4)
    v_mfma_f32_16x16x32_bf16 v[192:195], v[144:147], v[52:55], v[192:195]
    ds_read_b128 v[48:51], v62 offset:41472
    v_mfma_f32_16x16x32_bf16 v[196:199], v[148:151], v[52:55], v[196:199]
    v_mfma_f32_16x16x32_bf16 v[192:195], v[152:155], v[36:39], v[192:195]
    ds_read_b128 v[32:35], v0 offset:41472
    v_mfma_f32_16x16x32_bf16 v[196:199], v[156:159], v[36:39], v[196:199]
    s_setprio 1
    s_waitcnt vmcnt(4) lgkmcnt(4)
    v_mfma_f32_16x16x32_bf16 v[192:195], v[160:163], v[58:61], v[192:195]
    ds_read_b128 v[52:55], v63 offset:41472
    v_mfma_f32_16x16x32_bf16 v[196:199], v[164:167], v[58:61], v[196:199]
    v_mfma_f32_16x16x32_bf16 v[192:195], v[168:171], v[40:43], v[192:195]
    ds_read_b128 v[36:39], v2 offset:41472
    v_mfma_f32_16x16x32_bf16 v[196:199], v[172:175], v[40:43], v[196:199]
    s_waitcnt vmcnt(0) lgkmcnt(4)
    v_mfma_f32_16x16x32_bf16 v[192:195], v[176:179], v[10:13], v[192:195]
    ds_read_b128 v[58:61], v62 offset:41728
    v_mfma_f32_16x16x32_bf16 v[196:199], v[180:183], v[10:13], v[196:199]
    v_mfma_f32_16x16x32_bf16 v[192:195], v[184:187], v[44:47], v[192:195]
    ds_read_b128 v[40:43], v0 offset:41728
    v_mfma_f32_16x16x32_bf16 v[196:199], v[188:191], v[44:47], v[196:199]
    s_waitcnt lgkmcnt(4)
    v_mfma_f32_16x16x32_bf16 v[200:203], v[128:131], v[48:51], v[200:203]
    ds_read_b128 v[10:13], v63 offset:41728
    v_mfma_f32_16x16x32_bf16 v[204:207], v[132:135], v[48:51], v[204:207]
    v_mfma_f32_16x16x32_bf16 v[200:203], v[136:139], v[32:35], v[200:203]
    ds_read_b128 v[44:47], v2 offset:41728
    v_mfma_f32_16x16x32_bf16 v[204:207], v[140:143], v[32:35], v[204:207]
    s_waitcnt lgkmcnt(4)
    v_mfma_f32_16x16x32_bf16 v[200:203], v[144:147], v[52:55], v[200:203]
    ds_read_b128 v[48:51], v62 offset:57856
    v_mfma_f32_16x16x32_bf16 v[204:207], v[148:151], v[52:55], v[204:207]
    v_mfma_f32_16x16x32_bf16 v[200:203], v[152:155], v[36:39], v[200:203]
    ds_read_b128 v[32:35], v0 offset:57856
    v_cvt_pk_bf16_f32 v192, v192, v193
    v_mfma_f32_16x16x32_bf16 v[204:207], v[156:159], v[36:39], v[204:207]
    v_cvt_pk_bf16_f32 v193, v194, v195
    s_waitcnt lgkmcnt(4)
    v_mfma_f32_16x16x32_bf16 v[200:203], v[160:163], v[58:61], v[200:203]
    ds_read_b128 v[52:55], v63 offset:57856
    v_cvt_pk_bf16_f32 v194, v196, v197
    v_mfma_f32_16x16x32_bf16 v[204:207], v[164:167], v[58:61], v[204:207]
    v_cvt_pk_bf16_f32 v195, v198, v199
    buffer_store_dwordx4 v[192:195], v5, s[16:19], 0 offen sc0 sc1
    v_mfma_f32_16x16x32_bf16 v[200:203], v[168:171], v[40:43], v[200:203]
    ds_read_b128 v[36:39], v2 offset:57856
    v_mfma_f32_16x16x32_bf16 v[204:207], v[172:175], v[40:43], v[204:207]
    s_setprio 0
    s_waitcnt lgkmcnt(4)
    v_mfma_f32_16x16x32_bf16 v[200:203], v[176:179], v[10:13], v[200:203]
    ds_read_b128 v[58:61], v62 offset:58112
    v_mfma_f32_16x16x32_bf16 v[204:207], v[180:183], v[10:13], v[204:207]
    v_mfma_f32_16x16x32_bf16 v[200:203], v[184:187], v[44:47], v[200:203]
    ds_read_b128 v[40:43], v0 offset:58112
    v_mfma_f32_16x16x32_bf16 v[204:207], v[188:191], v[44:47], v[204:207]
    s_waitcnt lgkmcnt(4)
    v_mfma_f32_16x16x32_bf16 v[208:211], v[128:131], v[48:51], v[208:211]
    ds_read_b128 v[10:13], v63 offset:58112
    v_mfma_f32_16x16x32_bf16 v[212:215], v[132:135], v[48:51], v[212:215]
    v_mfma_f32_16x16x32_bf16 v[208:211], v[136:139], v[32:35], v[208:211]
    ds_read_b128 v[44:47], v2 offset:58112
    v_mfma_f32_16x16x32_bf16 v[212:215], v[140:143], v[32:35], v[212:215]
    s_waitcnt lgkmcnt(4)
    v_mfma_f32_16x16x32_bf16 v[208:211], v[144:147], v[52:55], v[208:211]
    v_mfma_f32_16x16x32_bf16 v[212:215], v[148:151], v[52:55], v[212:215]
    v_mfma_f32_16x16x32_bf16 v[208:211], v[152:155], v[36:39], v[208:211]
    v_add_u32 v5, 8192, v5
    v_cvt_pk_bf16_f32 v200, v200, v201
    v_mfma_f32_16x16x32_bf16 v[212:215], v[156:159], v[36:39], v[212:215]
    v_cvt_pk_bf16_f32 v201, v202, v203
    s_waitcnt lgkmcnt(2)
    v_mfma_f32_16x16x32_bf16 v[208:211], v[160:163], v[58:61], v[208:211]
    v_cvt_pk_bf16_f32 v202, v204, v205
    v_cvt_pk_bf16_f32 v203, v206, v207
    v_mfma_f32_16x16x32_bf16 v[212:215], v[164:167], v[58:61], v[212:215]
    buffer_store_dwordx4 v[200:203], v5, s[16:19], 0 offen sc0 sc1
    v_mfma_f32_16x16x32_bf16 v[208:211], v[168:171], v[40:43], v[208:211]
    v_mfma_f32_16x16x32_bf16 v[212:215], v[172:175], v[40:43], v[212:215]
    s_waitcnt lgkmcnt(0)
    v_mfma_f32_16x16x32_bf16 v[208:211], v[176:179], v[10:13], v[208:211]
    v_mfma_f32_16x16x32_bf16 v[212:215], v[180:183], v[10:13], v[212:215]
    v_mfma_f32_16x16x32_bf16 v[208:211], v[184:187], v[44:47], v[208:211]
    v_mfma_f32_16x16x32_bf16 v[212:215], v[188:191], v[44:47], v[212:215]
    s_nop 6
    v_add_u32 v5, 8192, v5
    v_cvt_pk_bf16_f32 v208, v208, v209
    v_cvt_pk_bf16_f32 v209, v210, v211
    v_cvt_pk_bf16_f32 v210, v212, v213
    v_cvt_pk_bf16_f32 v211, v214, v215
    buffer_store_dwordx4 v[208:211], v5, s[16:19], 0 offen sc0 sc1
    s_endpgm
AUX:
    s_memrealtime s[96:97]
    s_and_b32 s38, s2, 7
    s_mul_i32 s51, s38, 5000
    s_lshr_b32 s39, s2, 3
    s_waitcnt lgkmcnt(0)
    s_mov_b32 s8, s76
    s_and_b32 s9, s77, 0xffff
    s_mov_b32 s10, 5120000
    s_mov_b32 s11, 0x00020000
    s_cmp_lt_u32 s2, 32
    s_cbranch_scc1 PROD
    s_sub_u32 s39, s39, 4
    s_lshl_b32 s39, s39, 9
    s_add_u32 s51, s51, s39
    v_add_u32 v4, s51, v0
    s_sub_u32 s55, s2, 32
    s_cmp_lt_u32 s55, 8
    s_cbranch_scc0 H_PF
    s_mov_b32 s68, s88
    s_and_b32 s69, s89, 0xffff
    s_mov_b32 s70, 262144
    s_mov_b32 s71, 0x00020000
    s_mov_b32 s72, s6
    s_and_b32 s73, s7, 0xffff
    s_mov_b32 s74, 256
    s_mov_b32 s75, 0x00020000
    s_mov_b32 s12, s100
    s_and_b32 s13, s101, 0xffff
    s_mov_b32 s14, 2359296
    s_mov_b32 s15, 0x00020000
    s_lshl_b32 s37, s36, 12
    v_lshrrev_b32 v5, 2, v1
    v_lshlrev_b32 v5, 9, v5
    v_and_b32 v6, 3, v1
    v_lshl_or_b32 v5, v6, 4, v5
    s_lshl_b32 s38, s36, 6
    v_or_b32 v56, s38, v5
    v_lshl_add_u32 v63, v1, 4, s37
    s_lshl_b32 s38, s55, 15
    s_add_u32 m0, s37, 0
    s_add_u32 s45, s38, 0
    buffer_load_dwordx4 v56, s[68:71], s45 offen lds
    s_add_u32 m0, s37, 1024
    s_add_u32 s45, s38, 8192
    buffer_load_dwordx4 v56, s[68:71], s45 offen lds
    s_add_u32 m0, s37, 2048
    s_add_u32 s45, s38, 16384
    buffer_load_dwordx4 v56, s[68:71], s45 offen lds
    s_add_u32 m0, s37, 3072
    s_add_u32 s45, s38, 24576
    buffer_load_dwordx4 v56, s[68:71], s45 offen lds
    s_lshl_b32 s38, s36, 15
    s_lshl_b32 s45, s55, 12
    s_add_u32 s38, s38, s45
    s_add_u32 s38, s38, 2097152
    v_lshl_add_u32 v7, v1, 4, s38
    s_waitcnt vmcnt(0)
    ds_read_b64_tr_b16 v[64:65], v63 offset:0
    ds_read_b64_tr_b16 v[66:67], v63 offset:1024
    ds_read_b64_tr_b16 v[68:69], v63 offset:8
    ds_read_b64_tr_b16 v[70:71], v63 offset:1032
    ds_read_b64_tr_b16 v[72:73], v63 offset:2048
    ds_read_b64_tr_b16 v[74:75], v63 offset:3072
    ds_read_b64_tr_b16 v[76:77], v63 offset:2056
    ds_read_b64_tr_b16 v[78:79], v63 offset:3080
    s_waitcnt lgkmcnt(0)
    buffer_store_dwordx4 v[64:67], v7, s[12:15], 0 offen offset:0 sc1
    buffer_store_dwordx4 v[68:71], v7, s[12:15], 0 offen offset:1024 sc1
    buffer_store_dwordx4 v[72:75], v7, s[12:15], 0 offen offset:2048 sc1
    buffer_store_dwordx4 v[76:79], v7, s[12:15], 0 offen offset:3072 sc1
    s_waitcnt vmcnt(0)
    s_barrier
    s_cmp_eq_u32 s36, 0
    s_cbranch_scc0 H_PF
    s_lshl_b32 s38, s55, 2
    v_mov_b32 v6, s38
    v_mov_b32 v5, 1
    s_mov_b64 exec, 1
    buffer_store_dword v5, v6, s[72:75], 0 offen offset:128 sc1
    s_mov_b64 exec, -1
H_PF:
    v_add_u32 v5, 0, v4
    v_subrev_u32 v6, 40000, v5
    v_min_u32 v5, v5, v6
    v_lshlrev_b32 v5, 7, v5
    buffer_load_dword v16, v5, s[8:11], 0 offen
    v_add_u32 v5, 1024, v4
    v_subrev_u32 v6, 40000, v5
    v_min_u32 v5, v5, v6
    v_lshlrev_b32 v5, 7, v5
    buffer_load_dword v17, v5, s[8:11], 0 offen
    v_add_u32 v5, 2048, v4
    v_subrev_u32 v6, 40000, v5
    v_min_u32 v5, v5, v6
    v_lshlrev_b32 v5, 7, v5
    buffer_load_dword v18, v5, s[8:11], 0 offen
    v_add_u32 v5, 3072, v4
    v_subrev_u32 v6, 40000, v5
    v_min_u32 v5, v5, v6
    v_lshlrev_b32 v5, 7, v5
    buffer_load_dword v19, v5, s[8:11], 0 offen
    s_endpgm
PROD:
    s_mov_b32 s72, s6
    s_and_b32 s73, s7, 0xffff
    s_mov_b32 s74, 256
    s_mov_b32 s75, 0x00020000
    s_mov_b32 s12, s100
    s_and_b32 s13, s101, 0xffff
    s_mov_b32 s14, 1712128
    s_mov_b32 s15, 0x00020000
    v_lshrrev_b32 v46, 3, v0
    v_and_b32 v47, 7, v0
    v_lshlrev_b32 v50, 13, v46
    v_lshl_or_b32 v50, v47, 4, v50
    s_lshl_b32 s4, s2, 7
    v_add_u32 v50, s4, v50
    s_lshr_b32 s54, s96, 8
    s_or_b32 s54, s54, 1
    v_mov_b32 v51, 1024
    s_cmp_eq_u32 s36, 7
    s_cbranch_scc0 P_N1
    v_mov_b32 v5, s54
    s_lshl_b32 s4, s2, 2
    v_mov_b32 v6, s4
    s_mov_b64 exec, 1
    buffer_store_dword v5, v6, s[72:75], 0 offen sc1
    ds_write_b32 v51, v5
    s_mov_b64 exec, -1
P_N1:
    v_mov_b32 v40, 1032192
    v_mov_b32 v41, v40
    v_mov_b32 v42, v40
    v_mov_b32 v43, v40
    s_movk_i32 s4, 528
    v_mov_b32 v55, 2048
    v_mad_u32_u24 v56, v46, s4, v55
    v_lshl_add_u32 v48, v47, 4, v56
    v_add_u32 v49, 67584, v48
    ds_write_b128 v48, v[40:43] offset:0
    ds_write_b128 v48, v[40:43] offset:128
    ds_write_b128 v48, v[40:43] offset:33792
    ds_write_b128 v48, v[40:43] offset:33920
    ds_write_b128 v49, v[40:43] offset:0
    ds_write_b128 v49, v[40:43] offset:128
    ds_write_b128 v49, v[40:43] offset:33792
    ds_write_b128 v49, v[40:43] offset:33920
    v_and_b32 v5, 255, v0
    v_mad_u32_u24 v6, v5, s4, v55
    v_lshlrev_b32 v5, 2, v5
    ds_write_b32 v5, v6 offset:0
    v_mov_b32 v44, 4
    s_mov_b32 s52, 4294180864
    v_lshlrev_b32 v45, 2, v46
    v_mov_b32 v52, 1015808
    s_mov_b32 s38, 43691
    s_lshl_b32 s39, s39, 9
    s_add_u32 s51, s51, s39
    v_add_u32 v4, s51, v0
    v_add_u32 v72, 0, v50
    v_add_u32 v76, 128, v56
    v_add_u32 v73, 524288, v50
    v_add_u32 v77, 33920, v56
    v_add_u32 v74, 1048576, v50
    v_add_u32 v78, 67712, v56
    v_add_u32 v75, 1572864, v50
    v_add_u32 v79, 101504, v56
    v_lshlrev_b32 v5, 2, v1
    v_mad_u32_u24 v80, v5, s4, v55
    v_add_u32 v80, 512, v80
    v_lshlrev_b32 v84, 4, v1
    s_waitcnt lgkmcnt(0)
    s_barrier
    ds_read_b32 v53, v51
    s_waitcnt lgkmcnt(0)
    v_lshlrev_b32 v53, 8, v53
    s_cmp_eq_u32 s36, 7
    s_cbranch_scc1 P_W70
    s_waitcnt vmcnt(2)
P_W70:
    s_waitcnt vmcnt(3)
    v_mul_u32_u24 v192, s38, v16
    v_lshrrev_b32 v192, 21, v192
    v_lshlrev_b32 v204, 2, v192
    ds_add_rtn_u32 v204, v204, v44 offset:0
    v_mul_u32_u24 v193, s38, v17
    v_lshrrev_b32 v193, 21, v193
    v_lshlrev_b32 v205, 2, v193
    ds_add_rtn_u32 v205, v205, v44 offset:0
    v_mul_u32_u24 v194, s38, v18
    v_lshrrev_b32 v194, 21, v194
    v_lshlrev_b32 v206, 2, v194
    ds_add_rtn_u32 v206, v206, v44 offset:0
    v_mul_u32_u24 v195, s38, v19
    v_lshrrev_b32 v195, 21, v195
    v_lshlrev_b32 v207, 2, v195
    ds_add_rtn_u32 v207, v207, v44 offset:0
    v_mul_u32_u24 v196, s38, v24
    v_lshrrev_b32 v196, 21, v196
    v_lshlrev_b32 v208, 2, v196
    ds_add_rtn_u32 v208, v208, v44 offset:0
    v_mul_u32_u24 v197, s38, v25
    v_lshrrev_b32 v197, 21, v197
    v_lshlrev_b32 v209, 2, v197
    ds_add_rtn_u32 v209, v209, v44 offset:0
    v_mul_u32_u24 v198, s38, v26
    v_lshrrev_b32 v198, 21, v198
    v_lshlrev_b32 v210, 2, v198
    ds_add_rtn_u32 v210, v210, v44 offset:0
    v_mul_u32_u24 v199, s38, v27
    v_lshrrev_b32 v199, 21, v199
    v_lshlrev_b32 v211, 2, v199
    ds_add_rtn_u32 v211, v211, v44 offset:0
    s_cmp_lt_u32 s36, 4
    s_cbranch_scc0 P_R2
    v_cmp_gt_u32 vcc, 226, v0
    s_and_saveexec_b64 s[4:5], vcc
    v_mul_u32_u24 v200, s38, v32
    v_lshrrev_b32 v200, 21, v200
    v_lshlrev_b32 v212, 2, v200
    ds_add_rtn_u32 v212, v212, v44 offset:0
    v_mul_u32_u24 v201, s38, v33
    v_lshrrev_b32 v201, 21, v201
    v_lshlrev_b32 v213, 2, v201
    ds_add_rtn_u32 v213, v213, v44 offset:0
    v_mul_u32_u24 v202, s38, v34
    v_lshrrev_b32 v202, 21, v202
    v_lshlrev_b32 v214, 2, v202
    ds_add_rtn_u32 v214, v214, v44 offset:0
    v_mul_u32_u24 v203, s38, v35
    v_lshrrev_b32 v203, 21, v203
    v_lshlrev_b32 v215, 2, v203
    ds_add_rtn_u32 v215, v215, v44 offset:0
    v_lshl_or_b32 v36, v32, 14, v36
    v_mad_i32_i24 v36, v200, s52, v36
    v_lshl_or_b32 v37, v33, 14, v37
    v_mad_i32_i24 v37, v201, s52, v37
    v_lshl_or_b32 v38, v34, 14, v38
    v_mad_i32_i24 v38, v202, s52, v38
    v_lshl_or_b32 v39, v35, 14, v39
    v_mad_i32_i24 v39, v203, s52, v39
    s_waitcnt lgkmcnt(0)
    ds_write_b32 v212, v36
    ds_write_b32 v213, v37
    ds_write_b32 v214, v38
    ds_write_b32 v215, v39
    s_mov_b64 exec, s[4:5]
P_R2:
    s_cmp_eq_u32 s36, 7
    s_cbranch_scc1 P_W71
    s_waitcnt vmcnt(0)
P_W71:
    s_waitcnt vmcnt(1)
    v_lshl_or_b32 v20, v16, 14, v20
    v_mad_i32_i24 v20, v192, s52, v20
    v_lshl_or_b32 v21, v17, 14, v21
    v_mad_i32_i24 v21, v193, s52, v21
    v_lshl_or_b32 v22, v18, 14, v22
    v_mad_i32_i24 v22, v194, s52, v22
    v_lshl_or_b32 v23, v19, 14, v23
    v_mad_i32_i24 v23, v195, s52, v23
    v_lshl_or_b32 v28, v24, 14, v28
    v_mad_i32_i24 v28, v196, s52, v28
    v_lshl_or_b32 v29, v25, 14, v29
    v_mad_i32_i24 v29, v197, s52, v29
    v_lshl_or_b32 v30, v26, 14, v30
    v_mad_i32_i24 v30, v198, s52, v30
    v_lshl_or_b32 v31, v27, 14, v31
    v_mad_i32_i24 v31, v199, s52, v31
    s_waitcnt lgkmcnt(0)
    ds_write_b32 v204, v20
    ds_write_b32 v205, v21
    ds_write_b32 v206, v22
    ds_write_b32 v207, v23
    ds_write_b32 v208, v28
    ds_write_b32 v209, v29
    ds_write_b32 v210, v30
    ds_write_b32 v211, v31
    s_waitcnt lgkmcnt(0)
    s_barrier
    ds_read_b128 v[88:91], v84 offset:0
    ds_read_b128 v[128:131], v48 offset:0
    ds_read_b128 v[132:135], v48 offset:33792
    ds_read_b128 v[136:139], v49 offset:0
    ds_read_b128 v[140:143], v49 offset:33792
    ds_read_b32 v64, v45 offset:0
    ds_read_b128 v[144:147], v48 offset:128
    ds_read_b32 v65, v45 offset:256
    ds_read_b128 v[148:151], v48 offset:33920
    ds_read_b32 v66, v45 offset:512
    ds_read_b128 v[152:155], v49 offset:128
    ds_read_b32 v67, v45 offset:768
    ds_read_b128 v[156:159], v49 offset:33920
    s_waitcnt lgkmcnt(12)
    v_subrev_u32 v89, 528, v89
    v_subrev_u32 v90, 1056, v90
    v_subrev_u32 v91, 1584, v91
    v_max3_u32 v88, v88, v89, v90
    v_max_u32 v88, v88, v91
    v_cmp_gt_u32 vcc, v88, v80
    s_cmp_lg_u64 vcc, 0
    s_cbranch_scc1 P_OVF
P_OVR:
    s_waitcnt lgkmcnt(11)
    v_lshl_or_b32 v128, v129, 20, v128
    v_lshrrev_b32 v129, 12, v129
    v_or_b32 v129, v53, v129
    v_lshl_or_b32 v130, v131, 20, v130
    v_lshrrev_b32 v131, 12, v131
    v_or_b32 v131, v53, v131
    buffer_store_dwordx4 v[128:131], v72, s[12:15], 0 offen sc1
    s_waitcnt lgkmcnt(10)
    v_lshl_or_b32 v132, v133, 20, v132
    v_lshrrev_b32 v133, 12, v133
    v_or_b32 v133, v53, v133
    v_lshl_or_b32 v134, v135, 20, v134
    v_lshrrev_b32 v135, 12, v135
    v_or_b32 v135, v53, v135
    buffer_store_dwordx4 v[132:135], v73, s[12:15], 0 offen sc1
    s_waitcnt lgkmcnt(9)
    v_lshl_or_b32 v136, v137, 20, v136
    v_lshrrev_b32 v137, 12, v137
    v_or_b32 v137, v53, v137
    v_lshl_or_b32 v138, v139, 20, v138
    v_lshrrev_b32 v139, 12, v139
    v_or_b32 v139, v53, v139
    buffer_store_dwordx4 v[136:139], v74, s[12:15], 0 offen sc1
    s_waitcnt lgkmcnt(8)
    v_lshl_or_b32 v140, v141, 20, v140
    v_lshrrev_b32 v141, 12, v141
    v_or_b32 v141, v53, v141
    v_lshl_or_b32 v142, v143, 20, v142
    v_lshrrev_b32 v143, 12, v143
    v_or_b32 v143, v53, v143
    buffer_store_dwordx4 v[140:143], v75, s[12:15], 0 offen sc1
    s_movk_i32 s6, 0x1000
    s_waitcnt lgkmcnt(6)
    v_cmp_le_u32 vcc, v76, v64
    s_and_b64 exec, exec, vcc
    s_cbranch_scc0 P_SK0
    v_add_u32 v76, 128, v76
    v_cmp_lt_u32 vcc, v76, v64
    s_nop 1
    v_cndmask_b32 v144, v144, v52, vcc
    v_lshl_or_b32 v144, v145, 20, v144
    v_lshrrev_b32 v145, 12, v145
    v_or_b32 v145, v53, v145
    v_lshl_or_b32 v146, v147, 20, v146
    v_lshrrev_b32 v147, 12, v147
    v_or_b32 v147, v53, v147
    buffer_store_dwordx4 v[144:147], v72, s[12:15], s6 offen sc1
P_SK0:
    s_mov_b64 exec, -1
    s_waitcnt lgkmcnt(4)
    v_cmp_le_u32 vcc, v77, v65
    s_and_b64 exec, exec, vcc
    s_cbranch_scc0 P_SK1
    v_add_u32 v77, 128, v77
    v_cmp_lt_u32 vcc, v77, v65
    s_nop 1
    v_cndmask_b32 v148, v148, v52, vcc
    v_lshl_or_b32 v148, v149, 20, v148
    v_lshrrev_b32 v149, 12, v149
    v_or_b32 v149, v53, v149
    v_lshl_or_b32 v150, v151, 20, v150
    v_lshrrev_b32 v151, 12, v151
    v_or_b32 v151, v53, v151
    buffer_store_dwordx4 v[148:151], v73, s[12:15], s6 offen sc1
P_SK1:
    s_mov_b64 exec, -1
    s_waitcnt lgkmcnt(2)
    v_cmp_le_u32 vcc, v78, v66
    s_and_b64 exec, exec, vcc
    s_cbranch_scc0 P_SK2
    v_add_u32 v78, 128, v78
    v_cmp_lt_u32 vcc, v78, v66
    s_nop 1
    v_cndmask_b32 v152, v152, v52, vcc
    v_lshl_or_b32 v152, v153, 20, v152
    v_lshrrev_b32 v153, 12, v153
    v_or_b32 v153, v53, v153
    v_lshl_or_b32 v154, v155, 20, v154
    v_lshrrev_b32 v155, 12, v155
    v_or_b32 v155, v53, v155
    buffer_store_dwordx4 v[152:155], v74, s[12:15], s6 offen sc1
P_SK2:
    s_mov_b64 exec, -1
    s_waitcnt lgkmcnt(0)
    v_cmp_le_u32 vcc, v79, v67
    s_and_b64 exec, exec, vcc
    s_cbranch_scc0 P_SK3
    v_add_u32 v79, 128, v79
    v_cmp_lt_u32 vcc, v79, v67
    s_nop 1
    v_cndmask_b32 v156, v156, v52, vcc
    v_lshl_or_b32 v156, v157, 20, v156
    v_lshrrev_b32 v157, 12, v157
    v_or_b32 v157, v53, v157
    v_lshl_or_b32 v158, v159, 20, v158
    v_lshrrev_b32 v159, 12, v159
    v_or_b32 v159, v53, v159
    buffer_store_dwordx4 v[156:159], v75, s[12:15], s6 offen sc1
P_SK3:
    s_mov_b64 exec, -1
    s_barrier
    v_add_u32 v5, 4096, v4
    v_subrev_u32 v6, 40000, v5
    v_min_u32 v5, v5, v6
    v_lshlrev_b32 v5, 7, v5
    buffer_load_dword v16, v5, s[8:11], 0 offen
    s_endpgm
P_OVF:
    s_waitcnt lgkmcnt(0)
    v_mov_b32 v128, v52
    v_mov_b32 v64, -1
    v_mov_b32 v132, v52
    v_mov_b32 v65, -1
    v_mov_b32 v136, v52
    v_mov_b32 v66, -1
    v_mov_b32 v140, v52
    v_mov_b32 v67, -1
    s_branch P_OVR
M_END:
    s_endpgm
.section .rodata,"a"
.p2align 6
.amdhsa_kernel gather_scatter__isomorphism_gin_2__graph_kernel
  .amdhsa_next_free_vgpr 256
  .amdhsa_next_free_sgpr 102
  .amdhsa_accum_offset 256
  .amdhsa_group_segment_fixed_size 0
  .amdhsa_kernarg_size 88
  .amdhsa_user_sgpr_count 2
  .amdhsa_user_sgpr_kernarg_segment_ptr 1
  .amdhsa_system_sgpr_workgroup_id_x 1
.end_amdhsa_kernel
```
